```python
import torch

def _softmax(x, axis=-1):
    return torch.softmax(x, dim=axis)

def _gelu(x):
    return torch.nn.functional.gelu(x, approximate='tanh')

def _silu(x):
    return torch.nn.functional.silu(x)

def _sigmoid(x):
    return torch.sigmoid(x)

def _layernorm(x, axis=-1, eps=1e-05):
    m = x.mean(dim=axis, keepdim=True)
    v = x.var(dim=axis, keepdim=True, unbiased=False)
    return (x - m) / torch.sqrt(v + eps)

def _scatter_add(tgt, idx, src, axis=0):
    return tgt.clone().index_add_(axis, idx, src)

def _segment_sum(src, seg, n):
    out = torch.zeros((n,) + src.shape[1:], dtype=src.dtype)
    return out.index_add_(0, seg, src)

def _pad(x, pw):
    flat = tuple((v for pair in reversed(pw) for v in pair))
    return torch.nn.functional.pad(x, flat)
kernel_name = 'standalone__kv_cache_quant_pre_rope_vs_post_rope__sampling'

def setup_inputs():

    _w = lambda a: (lambda t: t.to(torch.bfloat16) if t.is_floating_point() else t)(torch.as_tensor(a))
    B, Sq, Skv = (8, 1, 8192)
    H, Dh0 = (8, 128)
    G = -1 if -1 > 0 else Dh0
    G = max(2, G // 2 * 2)
    Dh = max(G, Dh0 // G * G)
    Skv = max(Skv, Sq)
    ng = Dh // G
    bits = 4 if 4 > 1 else 4
    bits = max(2, min(8, bits))
    qmax = (1 << bits) - 1
    half = Dh // 2
    inv = 1.0 / 10000.0 ** (torch.arange(half) / max(1, half))
    ang_k = torch.arange(Skv)[:, None] * inv[None, :]
    ang_q = torch.arange(Skv - Sq, Skv)[:, None] * inv[None, :]
    kc = torch.cat([torch.cos(ang_k), torch.cos(ang_k)], dim=-1)
    ks = torch.cat([torch.sin(ang_k), torch.sin(ang_k)], dim=-1)
    qc = torch.cat([torch.cos(ang_q), torch.cos(ang_q)], dim=-1)
    qs = torch.cat([torch.sin(ang_q), torch.sin(ang_q)], dim=-1)
    qk_i = torch.randint(0, qmax + 1, (B, H, Skv, Dh)).to(torch.int32)
    qv_i = torch.randint(0, qmax + 1, (B, H, Skv, Dh)).to(torch.int32)
    ksc = torch.abs((lambda *s: torch.randn(*s, dtype=torch.bfloat16) * 0.2)(B, H, Skv, ng)) * 0.1 + 0.01
    kzp = torch.full((B, H, Skv, ng), qmax / 2.0)
    vsc = torch.abs((lambda *s: torch.randn(*s, dtype=torch.bfloat16) * 0.2)(B, H, Skv, ng)) * 0.1 + 0.01
    vzp = torch.full((B, H, Skv, ng), qmax / 2.0)
    return {'q': _w((lambda *s: torch.randn(*s, dtype=torch.bfloat16) * 6.4)(B, H, Sq, Dh) * 0.5), 'qk': _w(qk_i), 'k_scales': _w(ksc), 'k_zeros': _w(kzp), 'qv': _w(qv_i), 'v_scales': _w(vsc), 'v_zeros': _w(vzp), 'q_cos': _w(qc), 'q_sin': _w(qs), 'k_cos': _w(kc), 'k_sin': _w(ks)}

def reference(q, qk, k_scales, k_zeros, qv, v_scales, v_zeros, q_cos, q_sin, k_cos, k_sin):
    B, H, Sq, Dh = q.shape
    ng = k_scales.shape[-1]
    G = Dh // ng
    half = Dh // 2
    ks = (lambda x, n, axis: torch.repeat_interleave(x, n, dim=axis))(k_scales, G, axis=-1)
    kz = (lambda x, n, axis: torch.repeat_interleave(x, n, dim=axis))(k_zeros, G, axis=-1)
    k = ((lambda x, dt: x.to(dt))(qk, q.dtype) - kz) * ks
    vs = (lambda x, n, axis: torch.repeat_interleave(x, n, dim=axis))(v_scales, G, axis=-1)
    vz = (lambda x, n, axis: torch.repeat_interleave(x, n, dim=axis))(v_zeros, G, axis=-1)
    v = ((lambda x, dt: x.to(dt))(qv, q.dtype) - vz) * vs
    k1 = k[..., :half].clone()
    k2 = k[..., half:].clone()
    krh = torch.concatenate([-k2, k1], axis=-1)
    kr = k * k_cos[None, None, :, :] + krh * k_sin[None, None, :, :]
    q1 = q[..., :half].clone()
    q2 = q[..., half:].clone()
    qrh = torch.concatenate([-q2, q1], axis=-1)
    qr = q * q_cos[None, None, :, :] + qrh * q_sin[None, None, :, :]
    logits = torch.einsum('bhqd,bhkd->bhqk', qr, kr) * float(Dh) ** (-0.5)
    attn = _softmax(logits, axis=-1)
    out = torch.einsum('bhqk,bhkd->bhqd', attn, v)
    return out
```

```asm
; @launch grid=(256,1,1) block=(256,1,1) lds=98304
.amdgcn_target "amdgcn-amd-amdhsa--gfx950"
.text
.globl standalone__kv_cache_quant_pre_rope_vs_post_rope__sampling_kernel
.p2align 8
.type standalone__kv_cache_quant_pre_rope_vs_post_rope__sampling_kernel,@function
standalone__kv_cache_quant_pre_rope_vs_post_rope__sampling_kernel:
    s_load_dwordx16 s[4:19], s[0:1], 0
    s_load_dwordx8 s[20:27], s[0:1], 64
    s_load_dwordx4 s[28:31], s[0:1], 96
    s_cmp_ge_u32 s2, 256
    s_cbranch_scc1 L_end
    v_and_b32 v1, 63, v0
    v_lshrrev_b32 v2, 6, v0
    s_lshr_b32 s48, s2, 4
    s_and_b32 s49, s2, 15
    v_readfirstlane_b32 s50, v2
    v_lshlrev_b32 v4, 4, v1
    v_lshlrev_b32 v5, 3, v1
    v_add_u32 v6, 0x0, v4
    v_add_u32 v7, 0x400000, v4
    v_add_u32 v8, 0x800000, v4
    v_add_u32 v9, 0xc00000, v4
    v_add_u32 v10, 0x4000, v4
    v_add_u32 v11, 0x404000, v4
    v_add_u32 v12, 0x804000, v4
    v_add_u32 v13, 0xc04000, v4
    s_mul_i32 s51, s50, 4096
    s_mul_i32 s56, s49, 262144
    s_add_u32 s51, s51, s56
    s_mov_b32 s58, s51
    s_mov_b32 s54, 0x05040100
    s_mov_b32 s55, 0x07060302
    s_mov_b32 s59, 0x3e0293ee
    v_and_b32 v136, 0xf0, v4
    v_lshrrev_b32 v138, 4, v1
    v_lshl_add_u32 v138, v138, 8, v136
    v_mov_b32 v137, v138
    s_mul_i32 s56, s48, 1024
    v_add_u32 v138, s56, v138
    v_xor_b32 v139, 0x80, v138
    v_lshrrev_b32 v140, 4, v1
    v_and_b32 v141, 15, v1
    v_mul_u32_u24 v142, 64, v141
    v_lshl_add_u32 v142, v140, 14, v142
    s_mul_i32 s56, s48, 65536
    s_mul_i32 s57, s49, 1024
    s_add_u32 s56, s56, s57
    s_mul_i32 s57, s50, 16
    s_add_u32 s56, s56, s57
    v_add_u32 v142, s56, v142
    s_getpc_b64 s[90:91]
L_pc:
    s_add_u32 s90, s90, L_const-L_pc
    s_addc_u32 s91, s91, 0
    v_and_b32 v3, 0xf0, v4
    global_load_dwordx4 v[228:231], v3, s[90:91]
    v_and_b32 v2, 0x70, v4
    global_load_dwordx4 v[168:171], v2, s[90:91] offset:256
    global_load_dwordx4 v[172:175], v2, s[90:91] offset:384
    s_waitcnt lgkmcnt(0)
    global_load_dwordx4 v[160:163], v138, s[4:5]
    global_load_dwordx4 v[164:167], v139, s[4:5]
    s_mul_hi_u32 s60, s48, 0x1000000
    s_mul_i32 s56, s48, 0x1000000
    s_add_u32 s32, s6, s56
    s_addc_u32 s33, s7, s60
    s_and_b32 s33, s33, 0xffff
    s_mov_b32 s34, 0x1000000
    s_mov_b32 s35, 0x20000
    s_add_u32 s36, s12, s56
    s_addc_u32 s37, s13, s60
    s_and_b32 s37, s37, 0xffff
    s_mov_b32 s38, 0x1000000
    s_mov_b32 s39, 0x20000
    v_mov_b32 v224, v142
    global_load_dwordx4 v[204:207], v224, s[8:9] offset:0 nt
    global_load_dwordx4 v[208:211], v224, s[14:15] offset:0 nt
    buffer_load_dwordx4 v[40:43], v6, s[32:35], s51 offen offset:0 nt
    buffer_load_dwordx4 v[44:47], v6, s[32:35], s51 offen offset:1024 nt
    buffer_load_dwordx4 v[48:51], v6, s[32:35], s51 offen offset:2048 nt
    buffer_load_dwordx4 v[52:55], v6, s[32:35], s51 offen offset:3072 nt
    buffer_load_dwordx4 v[56:59], v7, s[32:35], s51 offen offset:0 nt
    buffer_load_dwordx4 v[60:63], v7, s[32:35], s51 offen offset:1024 nt
    s_lshl_b32 s56, s48, 7
    s_add_u32 s56, s56, 0x100000
    v_mov_b32 v226, s56
    global_load_dword v225, v226, s[30:31] sc0 sc1
    s_lshl_b32 s56, s48, 2
    v_mov_b32 v223, s56
    global_load_dword v220, v223, s[26:27]
    global_load_dword v221, v223, s[28:29] sc0 sc1
    s_mul_i32 s62, s50, 4096
    v_lshrrev_b32 v2, 5, v1
    v_mul_u32_u24 v36, 256, v2
    v_add_u32 v36, s62, v36
    v_bfe_u32 v144, v1, 4, 1
    v_bfe_u32 v145, v1, 3, 1
    v_bfe_u32 v146, v1, 2, 1
    v_lshl_add_u32 v144, v145, 1, v144
    v_lshl_add_u32 v144, v146, 2, v144
    v_lshrrev_b32 v145, 2, v144
    v_and_b32 v144, 3, v144
    v_lshl_add_u32 v144, v144, 1, v2
    s_nop 0
    v_mul_u32_u24 v145, 128, v145
    v_add_u32 v144, v144, v145
    v_lshlrev_b32 v144, 2, v144
    s_add_u32 s57, s62, 2048
    v_add_u32 v37, s57, v144
    v_mul_u32_u24 v38, 512, v140
    v_mul_u32_u24 v145, 16, v141
    v_add3_u32 v38, v38, v145, s62
    v_mul_u32_u24 v39, 32, v1
    v_add_u32 v39, s57, v39
    v_mov_b32 v188, 0
    v_mov_b32 v189, 0
    v_mov_b32 v190, 0
    v_mov_b32 v191, 0
    v_mov_b32 v192, 0
    v_mov_b32 v193, 0
    v_mov_b32 v194, 0
    v_mov_b32 v195, 0
    v_mov_b32 v196, 0
    v_mov_b32 v197, 0
    v_mov_b32 v198, 0
    v_mov_b32 v199, 0
    v_mov_b32 v200, 0
    v_mov_b32 v201, 0
    v_mov_b32 v202, 0
    v_mov_b32 v203, 0
    s_lshr_b32 s56, s58, 9
    v_add_u32 v232, s56, v2
    v_cvt_f32_u32 v232, v232
    s_mov_b32 s40, 0x3e22f983
    s_mov_b32 s41, 0x3e22f983
    s_mov_b32 s42, 0x31dc9c88
    s_mov_b32 s43, 0x31dc9c88
    s_waitcnt vmcnt(11)
    v_bfe_u32 v147, v1, 3, 1
    v_subrev_u32 v147, 1, v147
    v_and_b32 v147, 0x80008000, v147
    v_xor_b32 v172, v172, v147
    v_xor_b32 v173, v173, v147
    v_xor_b32 v174, v174, v147
    v_xor_b32 v175, v175, v147
    v_lshlrev_b32 v148, 16, v160
    v_and_b32 v149, 0xffff0000, v160
    v_lshlrev_b32 v150, 16, v168
    v_and_b32 v151, 0xffff0000, v168
    v_lshlrev_b32 v152, 16, v164
    v_and_b32 v153, 0xffff0000, v164
    v_lshlrev_b32 v154, 16, v172
    v_and_b32 v155, 0xffff0000, v172
    v_pk_mul_f32 v[148:149], v[148:149], v[150:151]
    v_pk_mul_f32 v[152:153], v[152:153], v[154:155]
    v_cvt_pk_bf16_f32 v150, v148, v149
    v_cvt_pk_bf16_f32 v154, v152, v153
    v_lshlrev_b32 v148, 16, v150
    v_and_b32 v149, 0xffff0000, v150
    v_lshlrev_b32 v152, 16, v154
    v_and_b32 v153, 0xffff0000, v154
    v_pk_add_f32 v[148:149], v[148:149], v[152:153]
    v_cvt_pk_bf16_f32 v176, v148, v149
    v_lshlrev_b32 v148, 16, v161
    v_and_b32 v149, 0xffff0000, v161
    v_lshlrev_b32 v150, 16, v169
    v_and_b32 v151, 0xffff0000, v169
    v_lshlrev_b32 v152, 16, v165
    v_and_b32 v153, 0xffff0000, v165
    v_lshlrev_b32 v154, 16, v173
    v_and_b32 v155, 0xffff0000, v173
    v_pk_mul_f32 v[148:149], v[148:149], v[150:151]
    v_pk_mul_f32 v[152:153], v[152:153], v[154:155]
    v_cvt_pk_bf16_f32 v150, v148, v149
    v_cvt_pk_bf16_f32 v154, v152, v153
    v_lshlrev_b32 v148, 16, v150
    v_and_b32 v149, 0xffff0000, v150
    v_lshlrev_b32 v152, 16, v154
    v_and_b32 v153, 0xffff0000, v154
    v_pk_add_f32 v[148:149], v[148:149], v[152:153]
    v_cvt_pk_bf16_f32 v177, v148, v149
    v_lshlrev_b32 v148, 16, v162
    v_and_b32 v149, 0xffff0000, v162
    v_lshlrev_b32 v150, 16, v170
    v_and_b32 v151, 0xffff0000, v170
    v_lshlrev_b32 v152, 16, v166
    v_and_b32 v153, 0xffff0000, v166
    v_lshlrev_b32 v154, 16, v174
    v_and_b32 v155, 0xffff0000, v174
    v_pk_mul_f32 v[148:149], v[148:149], v[150:151]
    v_pk_mul_f32 v[152:153], v[152:153], v[154:155]
    v_cvt_pk_bf16_f32 v150, v148, v149
    v_cvt_pk_bf16_f32 v154, v152, v153
    v_lshlrev_b32 v148, 16, v150
    v_and_b32 v149, 0xffff0000, v150
    v_lshlrev_b32 v152, 16, v154
    v_and_b32 v153, 0xffff0000, v154
    v_pk_add_f32 v[148:149], v[148:149], v[152:153]
    v_cvt_pk_bf16_f32 v178, v148, v149
    v_lshlrev_b32 v148, 16, v163
    v_and_b32 v149, 0xffff0000, v163
    v_lshlrev_b32 v150, 16, v171
    v_and_b32 v151, 0xffff0000, v171
    v_lshlrev_b32 v152, 16, v167
    v_and_b32 v153, 0xffff0000, v167
    v_lshlrev_b32 v154, 16, v175
    v_and_b32 v155, 0xffff0000, v175
    v_pk_mul_f32 v[148:149], v[148:149], v[150:151]
    v_pk_mul_f32 v[152:153], v[152:153], v[154:155]
    v_cvt_pk_bf16_f32 v150, v148, v149
    v_cvt_pk_bf16_f32 v154, v152, v153
    v_lshlrev_b32 v148, 16, v150
    v_and_b32 v149, 0xffff0000, v150
    v_lshlrev_b32 v152, 16, v154
    v_and_b32 v153, 0xffff0000, v154
    v_pk_add_f32 v[148:149], v[148:149], v[152:153]
    v_cvt_pk_bf16_f32 v179, v148, v149
    v_add_u32 v137, s57, v137
    ds_write_b128 v137, v[176:179]
    v_and_b32 v148, 0xf8, v5
    v_xor_b32 v149, 0x80, v148
    v_add_u32 v148, s57, v148
    v_add_u32 v149, s57, v149
    ds_read_b64 v[160:161], v148 offset:0
    ds_read_b64 v[162:163], v149 offset:0
    ds_read_b64 v[164:165], v148 offset:256
    ds_read_b64 v[166:167], v149 offset:256
    ds_read_b64 v[168:169], v148 offset:512
    ds_read_b64 v[170:171], v149 offset:512
    ds_read_b64 v[172:173], v148 offset:768
    ds_read_b64 v[174:175], v149 offset:768
    v_bfe_u32 v147, v1, 4, 1
    v_sub_u32 v147, 0, v147
    v_and_b32 v147, 0x80008000, v147
    s_waitcnt lgkmcnt(0)
    v_xor_b32 v162, v162, v147
    v_xor_b32 v163, v163, v147
    v_perm_b32 v20, v162, v160, s54
    v_perm_b32 v21, v162, v160, s55
    v_perm_b32 v22, v163, v161, s54
    v_perm_b32 v23, v163, v161, s55
    v_xor_b32 v166, v166, v147
    v_xor_b32 v167, v167, v147
    v_perm_b32 v24, v166, v164, s54
    v_perm_b32 v25, v166, v164, s55
    v_perm_b32 v26, v167, v165, s54
    v_perm_b32 v27, v167, v165, s55
    v_xor_b32 v170, v170, v147
    v_xor_b32 v171, v171, v147
    v_perm_b32 v28, v170, v168, s54
    v_perm_b32 v29, v170, v168, s55
    v_perm_b32 v30, v171, v169, s54
    v_perm_b32 v31, v171, v169, s55
    v_xor_b32 v174, v174, v147
    v_xor_b32 v175, v175, v147
    v_perm_b32 v32, v174, v172, s54
    v_perm_b32 v33, v174, v172, s55
    v_perm_b32 v34, v175, v173, s54
    v_perm_b32 v35, v175, v173, s55
    s_mov_b32 s92, 0xc0f00000
    s_mov_b32 s93, 0xc0f00000
    s_mov_b32 s53, 15
    s_nop 4
L_kloop:
    buffer_load_dwordx4 v[64:67], v7, s[32:35], s51 offen offset:2048 nt
    v_pk_mul_f32 v[236:237], v[228:229], v[232:233] op_sel_hi:[1,0]
    v_pk_mul_f32 v[240:241], v[236:237], s[40:41]
    v_pk_fma_f32 v[244:245], v[236:237], s[40:41], v[240:241] neg_lo:[0,0,1] neg_hi:[0,0,1]
    v_pk_fma_f32 v[244:245], v[236:237], s[42:43], v[244:245]
    v_fract_f32 v240, v240
    v_fract_f32 v241, v241
    v_pk_add_f32 v[240:241], v[240:241], v[244:245]
    v_cos_f32 v236, v240
    v_cos_f32 v237, v241
    v_sin_f32 v240, v240
    v_sin_f32 v241, v241
    v_pk_mul_f32 v[238:239], v[230:231], v[232:233] op_sel_hi:[1,0]
    v_pk_mul_f32 v[242:243], v[238:239], s[40:41]
    v_pk_fma_f32 v[244:245], v[238:239], s[40:41], v[242:243] neg_lo:[0,0,1] neg_hi:[0,0,1]
    v_pk_fma_f32 v[244:245], v[238:239], s[42:43], v[244:245]
    v_fract_f32 v242, v242
    v_fract_f32 v243, v243
    v_pk_add_f32 v[242:243], v[242:243], v[244:245]
    v_cos_f32 v238, v242
    v_cos_f32 v239, v243
    v_sin_f32 v242, v242
    v_sin_f32 v243, v243
    v_cvt_pk_bf16_f32 v120, v236, v240
    v_cvt_pk_bf16_f32 v121, v237, v241
    v_cvt_pk_bf16_f32 v122, v238, v242
    v_cvt_pk_bf16_f32 v123, v239, v243
    s_waitcnt vmcnt(6)
    v_dot2_f32_bf16 v144, v120, v20, 0
    v_dot2_f32_bf16 v145, v121, v21, 0
    v_dot2_f32_bf16 v146, v122, v22, 0
    v_dot2_f32_bf16 v147, v123, v23, 0
    v_cvt_f32_i32 v136, v40
    v_cvt_f32_i32 v137, v41
    v_cvt_f32_i32 v138, v42
    v_cvt_f32_i32 v139, v43
    v_pk_add_f32 v[136:137], v[136:137], s[92:93]
    v_pk_add_f32 v[138:139], v[138:139], s[92:93]
    v_pk_mul_f32 v[152:153], v[136:137], v[144:145]
    v_pk_fma_f32 v[152:153], v[138:139], v[146:147], v[152:153]
    v_add_f32 v156, v152, v153
    buffer_load_dwordx4 v[68:71], v7, s[32:35], s51 offen offset:3072 nt
    v_add_f32 v234, 0x40000000, v232
    v_pk_mul_f32 v[236:237], v[228:229], v[234:235] op_sel_hi:[1,0]
    v_pk_mul_f32 v[240:241], v[236:237], s[40:41]
    v_pk_fma_f32 v[244:245], v[236:237], s[40:41], v[240:241] neg_lo:[0,0,1] neg_hi:[0,0,1]
    v_pk_fma_f32 v[244:245], v[236:237], s[42:43], v[244:245]
    v_fract_f32 v240, v240
    v_fract_f32 v241, v241
    v_pk_add_f32 v[240:241], v[240:241], v[244:245]
    v_cos_f32 v236, v240
    v_cos_f32 v237, v241
    v_sin_f32 v240, v240
    v_sin_f32 v241, v241
    v_pk_mul_f32 v[238:239], v[230:231], v[234:235] op_sel_hi:[1,0]
    v_pk_mul_f32 v[242:243], v[238:239], s[40:41]
    v_pk_fma_f32 v[244:245], v[238:239], s[40:41], v[242:243] neg_lo:[0,0,1] neg_hi:[0,0,1]
    v_pk_fma_f32 v[244:245], v[238:239], s[42:43], v[244:245]
    v_fract_f32 v242, v242
    v_fract_f32 v243, v243
    v_pk_add_f32 v[242:243], v[242:243], v[244:245]
    v_cos_f32 v238, v242
    v_cos_f32 v239, v243
    v_sin_f32 v242, v242
    v_sin_f32 v243, v243
    v_cvt_pk_bf16_f32 v124, v236, v240
    v_cvt_pk_bf16_f32 v125, v237, v241
    v_cvt_pk_bf16_f32 v126, v238, v242
    v_cvt_pk_bf16_f32 v127, v239, v243
    s_waitcnt vmcnt(6)
    v_dot2_f32_bf16 v148, v124, v20, 0
    v_dot2_f32_bf16 v149, v125, v21, 0
    v_dot2_f32_bf16 v150, v126, v22, 0
    v_dot2_f32_bf16 v151, v127, v23, 0
    v_cvt_f32_i32 v140, v44
    v_cvt_f32_i32 v141, v45
    v_cvt_f32_i32 v142, v46
    v_cvt_f32_i32 v143, v47
    v_pk_add_f32 v[140:141], v[140:141], s[92:93]
    v_pk_add_f32 v[142:143], v[142:143], s[92:93]
    v_pk_mul_f32 v[154:155], v[140:141], v[148:149]
    v_pk_fma_f32 v[154:155], v[142:143], v[150:151], v[154:155]
    v_add_f32 v157, v154, v155
    buffer_load_dwordx4 v[72:75], v8, s[32:35], s51 offen offset:0 nt
    v_add_f32 v234, 0x40800000, v232
    v_permlane16_swap_b32 v156, v157
    v_add_f32 v156, v156, v157
    v_pk_mul_f32 v[236:237], v[228:229], v[234:235] op_sel_hi:[1,0]
    v_pk_mul_f32 v[240:241], v[236:237], s[40:41]
    v_pk_fma_f32 v[244:245], v[236:237], s[40:41], v[240:241] neg_lo:[0,0,1] neg_hi:[0,0,1]
    v_pk_fma_f32 v[244:245], v[236:237], s[42:43], v[244:245]
    v_fract_f32 v240, v240
    v_fract_f32 v241, v241
    v_pk_add_f32 v[240:241], v[240:241], v[244:245]
    v_cos_f32 v236, v240
    v_cos_f32 v237, v241
    v_sin_f32 v240, v240
    v_sin_f32 v241, v241
    v_pk_mul_f32 v[238:239], v[230:231], v[234:235] op_sel_hi:[1,0]
    v_pk_mul_f32 v[242:243], v[238:239], s[40:41]
    v_pk_fma_f32 v[244:245], v[238:239], s[40:41], v[242:243] neg_lo:[0,0,1] neg_hi:[0,0,1]
    v_pk_fma_f32 v[244:245], v[238:239], s[42:43], v[244:245]
    v_fract_f32 v242, v242
    v_fract_f32 v243, v243
    v_pk_add_f32 v[242:243], v[242:243], v[244:245]
    v_cos_f32 v238, v242
    v_cos_f32 v239, v243
    v_sin_f32 v242, v242
    v_sin_f32 v243, v243
    v_cvt_pk_bf16_f32 v128, v236, v240
    v_cvt_pk_bf16_f32 v129, v237, v241
    v_cvt_pk_bf16_f32 v130, v238, v242
    v_cvt_pk_bf16_f32 v131, v239, v243
    s_waitcnt vmcnt(6)
    v_dot2_f32_bf16 v144, v128, v20, 0
    v_dot2_f32_bf16 v145, v129, v21, 0
    v_dot2_f32_bf16 v146, v130, v22, 0
    v_dot2_f32_bf16 v147, v131, v23, 0
    v_cvt_f32_i32 v136, v48
    v_cvt_f32_i32 v137, v49
    v_cvt_f32_i32 v138, v50
    v_cvt_f32_i32 v139, v51
    v_pk_add_f32 v[136:137], v[136:137], s[92:93]
    v_pk_add_f32 v[138:139], v[138:139], s[92:93]
    v_pk_mul_f32 v[152:153], v[136:137], v[144:145]
    v_pk_fma_f32 v[152:153], v[138:139], v[146:147], v[152:153]
    v_add_f32 v158, v152, v153
    buffer_load_dwordx4 v[76:79], v8, s[32:35], s51 offen offset:1024 nt
    v_add_f32 v234, 0x40c00000, v232
    v_pk_mul_f32 v[236:237], v[228:229], v[234:235] op_sel_hi:[1,0]
    v_pk_mul_f32 v[240:241], v[236:237], s[40:41]
    v_pk_fma_f32 v[244:245], v[236:237], s[40:41], v[240:241] neg_lo:[0,0,1] neg_hi:[0,0,1]
    v_pk_fma_f32 v[244:245], v[236:237], s[42:43], v[244:245]
    v_fract_f32 v240, v240
    v_fract_f32 v241, v241
    v_pk_add_f32 v[240:241], v[240:241], v[244:245]
    v_cos_f32 v236, v240
    v_cos_f32 v237, v241
    v_sin_f32 v240, v240
    v_sin_f32 v241, v241
    v_pk_mul_f32 v[238:239], v[230:231], v[234:235] op_sel_hi:[1,0]
    v_pk_mul_f32 v[242:243], v[238:239], s[40:41]
    v_pk_fma_f32 v[244:245], v[238:239], s[40:41], v[242:243] neg_lo:[0,0,1] neg_hi:[0,0,1]
    v_pk_fma_f32 v[244:245], v[238:239], s[42:43], v[244:245]
    v_fract_f32 v242, v242
    v_fract_f32 v243, v243
    v_pk_add_f32 v[242:243], v[242:243], v[244:245]
    v_cos_f32 v238, v242
    v_cos_f32 v239, v243
    v_sin_f32 v242, v242
    v_sin_f32 v243, v243
    v_cvt_pk_bf16_f32 v132, v236, v240
    v_cvt_pk_bf16_f32 v133, v237, v241
    v_cvt_pk_bf16_f32 v134, v238, v242
    v_cvt_pk_bf16_f32 v135, v239, v243
    s_waitcnt vmcnt(6)
    v_dot2_f32_bf16 v148, v132, v20, 0
    v_dot2_f32_bf16 v149, v133, v21, 0
    v_dot2_f32_bf16 v150, v134, v22, 0
    v_dot2_f32_bf16 v151, v135, v23, 0
    v_cvt_f32_i32 v140, v52
    v_cvt_f32_i32 v141, v53
    v_cvt_f32_i32 v142, v54
    v_cvt_f32_i32 v143, v55
    v_pk_add_f32 v[140:141], v[140:141], s[92:93]
    v_pk_add_f32 v[142:143], v[142:143], s[92:93]
    v_pk_mul_f32 v[154:155], v[140:141], v[148:149]
    v_pk_fma_f32 v[154:155], v[142:143], v[150:151], v[154:155]
    v_add_f32 v159, v154, v155
    buffer_load_dwordx4 v[80:83], v8, s[32:35], s51 offen offset:2048 nt
    s_waitcnt vmcnt(6)
    v_permlane16_swap_b32 v158, v159
    v_add_f32 v158, v158, v159
    v_add_f32_dpp v156, v156, v156 row_ror:8 row_mask:0xf bank_mask:0x3
    v_dot2_f32_bf16 v144, v120, v24, 0
    v_dot2_f32_bf16 v145, v121, v25, 0
    v_add_f32_dpp v156, v158, v158 row_ror:8 row_mask:0xf bank_mask:0xc
    v_dot2_f32_bf16 v146, v122, v26, 0
    v_dot2_f32_bf16 v147, v123, v27, 0
    v_cvt_f32_i32 v136, v56
    v_cvt_f32_i32 v137, v57
    v_cvt_f32_i32 v138, v58
    v_cvt_f32_i32 v139, v59
    v_pk_add_f32 v[136:137], v[136:137], s[92:93]
    v_pk_add_f32 v[138:139], v[138:139], s[92:93]
    v_pk_mul_f32 v[152:153], v[136:137], v[144:145]
    v_pk_fma_f32 v[152:153], v[138:139], v[146:147], v[152:153]
    v_add_f32 v160, v152, v153
    buffer_load_dwordx4 v[84:87], v8, s[32:35], s51 offen offset:3072 nt
    s_waitcnt vmcnt(6)
    v_dot2_f32_bf16 v148, v124, v24, 0
    v_dot2_f32_bf16 v149, v125, v25, 0
    v_dot2_f32_bf16 v150, v126, v26, 0
    v_dot2_f32_bf16 v151, v127, v27, 0
    v_cvt_f32_i32 v140, v60
    v_cvt_f32_i32 v141, v61
    v_cvt_f32_i32 v142, v62
    v_cvt_f32_i32 v143, v63
    v_pk_add_f32 v[140:141], v[140:141], s[92:93]
    v_pk_add_f32 v[142:143], v[142:143], s[92:93]
    v_pk_mul_f32 v[154:155], v[140:141], v[148:149]
    v_pk_fma_f32 v[154:155], v[142:143], v[150:151], v[154:155]
    v_add_f32 v161, v154, v155
    buffer_load_dwordx4 v[88:91], v9, s[32:35], s51 offen offset:0 nt
    s_waitcnt vmcnt(6)
    v_permlane16_swap_b32 v160, v161
    v_add_f32 v160, v160, v161
    v_dot2_f32_bf16 v144, v128, v24, 0
    v_dot2_f32_bf16 v145, v129, v25, 0
    v_dot2_f32_bf16 v146, v130, v26, 0
    v_dot2_f32_bf16 v147, v131, v27, 0
    v_cvt_f32_i32 v136, v64
    v_cvt_f32_i32 v137, v65
    v_cvt_f32_i32 v138, v66
    v_cvt_f32_i32 v139, v67
    v_pk_add_f32 v[136:137], v[136:137], s[92:93]
    v_pk_add_f32 v[138:139], v[138:139], s[92:93]
    v_pk_mul_f32 v[152:153], v[136:137], v[144:145]
    v_pk_fma_f32 v[152:153], v[138:139], v[146:147], v[152:153]
    v_add_f32 v162, v152, v153
    buffer_load_dwordx4 v[92:95], v9, s[32:35], s51 offen offset:1024 nt
    s_waitcnt vmcnt(6)
    v_dot2_f32_bf16 v148, v132, v24, 0
    v_dot2_f32_bf16 v149, v133, v25, 0
    v_dot2_f32_bf16 v150, v134, v26, 0
    v_dot2_f32_bf16 v151, v135, v27, 0
    v_cvt_f32_i32 v140, v68
    v_cvt_f32_i32 v141, v69
    v_cvt_f32_i32 v142, v70
    v_cvt_f32_i32 v143, v71
    v_pk_add_f32 v[140:141], v[140:141], s[92:93]
    v_pk_add_f32 v[142:143], v[142:143], s[92:93]
    v_pk_mul_f32 v[154:155], v[140:141], v[148:149]
    v_pk_fma_f32 v[154:155], v[142:143], v[150:151], v[154:155]
    v_add_f32 v163, v154, v155
    buffer_load_dwordx4 v[96:99], v9, s[32:35], s51 offen offset:2048 nt
    s_waitcnt vmcnt(6)
    v_permlane16_swap_b32 v162, v163
    v_add_f32 v162, v162, v163
    v_add_f32_dpp v160, v160, v160 row_ror:8 row_mask:0xf bank_mask:0x3
    v_dot2_f32_bf16 v144, v120, v28, 0
    v_dot2_f32_bf16 v145, v121, v29, 0
    v_add_f32_dpp v160, v162, v162 row_ror:8 row_mask:0xf bank_mask:0xc
    v_add_f32_dpp v156, v156, v156 row_half_mirror row_mask:0xf bank_mask:0x5
    v_dot2_f32_bf16 v146, v122, v30, 0
    v_dot2_f32_bf16 v147, v123, v31, 0
    v_add_f32_dpp v156, v160, v160 row_half_mirror row_mask:0xf bank_mask:0xa
    v_cvt_f32_i32 v136, v72
    v_cvt_f32_i32 v137, v73
    v_add_f32_dpp v156, v156, v156 quad_perm:[2,3,0,1] row_mask:0xf bank_mask:0xf
    v_cvt_f32_i32 v138, v74
    v_cvt_f32_i32 v139, v75
    v_add_f32_dpp v156, v156, v156 quad_perm:[1,0,3,2] row_mask:0xf bank_mask:0xf
    ds_write_b32 v37, v156 offset:0
    v_pk_add_f32 v[136:137], v[136:137], s[92:93]
    v_pk_add_f32 v[138:139], v[138:139], s[92:93]
    v_pk_mul_f32 v[152:153], v[136:137], v[144:145]
    v_pk_fma_f32 v[152:153], v[138:139], v[146:147], v[152:153]
    v_add_f32 v164, v152, v153
    buffer_load_dwordx4 v[100:103], v9, s[32:35], s51 offen offset:3072 nt
    s_waitcnt vmcnt(6)
    v_dot2_f32_bf16 v148, v124, v28, 0
    v_dot2_f32_bf16 v149, v125, v29, 0
    v_dot2_f32_bf16 v150, v126, v30, 0
    v_dot2_f32_bf16 v151, v127, v31, 0
    v_cvt_f32_i32 v140, v76
    v_cvt_f32_i32 v141, v77
    v_cvt_f32_i32 v142, v78
    v_cvt_f32_i32 v143, v79
    v_pk_add_f32 v[140:141], v[140:141], s[92:93]
    v_pk_add_f32 v[142:143], v[142:143], s[92:93]
    v_pk_mul_f32 v[154:155], v[140:141], v[148:149]
    v_pk_fma_f32 v[154:155], v[142:143], v[150:151], v[154:155]
    v_add_f32 v165, v154, v155
    buffer_load_dwordx4 v[40:43], v10, s[32:35], s51 offen offset:0 nt
    s_waitcnt vmcnt(6)
    v_permlane16_swap_b32 v164, v165
    v_add_f32 v164, v164, v165
    v_dot2_f32_bf16 v144, v128, v28, 0
    v_dot2_f32_bf16 v145, v129, v29, 0
    v_dot2_f32_bf16 v146, v130, v30, 0
    v_dot2_f32_bf16 v147, v131, v31, 0
    v_cvt_f32_i32 v136, v80
    v_cvt_f32_i32 v137, v81
    v_cvt_f32_i32 v138, v82
    v_cvt_f32_i32 v139, v83
    v_pk_add_f32 v[136:137], v[136:137], s[92:93]
    v_pk_add_f32 v[138:139], v[138:139], s[92:93]
    v_pk_mul_f32 v[152:153], v[136:137], v[144:145]
    v_pk_fma_f32 v[152:153], v[138:139], v[146:147], v[152:153]
    v_add_f32 v166, v152, v153
    buffer_load_dwordx4 v[44:47], v10, s[32:35], s51 offen offset:1024 nt
    s_waitcnt vmcnt(6)
    v_dot2_f32_bf16 v148, v132, v28, 0
    v_dot2_f32_bf16 v149, v133, v29, 0
    v_dot2_f32_bf16 v150, v134, v30, 0
    v_dot2_f32_bf16 v151, v135, v31, 0
    v_cvt_f32_i32 v140, v84
    v_cvt_f32_i32 v141, v85
    v_cvt_f32_i32 v142, v86
    v_cvt_f32_i32 v143, v87
    v_pk_add_f32 v[140:141], v[140:141], s[92:93]
    v_pk_add_f32 v[142:143], v[142:143], s[92:93]
    v_pk_mul_f32 v[154:155], v[140:141], v[148:149]
    v_pk_fma_f32 v[154:155], v[142:143], v[150:151], v[154:155]
    v_add_f32 v167, v154, v155
    buffer_load_dwordx4 v[48:51], v10, s[32:35], s51 offen offset:2048 nt
    s_waitcnt vmcnt(6)
    v_permlane16_swap_b32 v166, v167
    v_add_f32 v166, v166, v167
    v_add_f32_dpp v164, v164, v164 row_ror:8 row_mask:0xf bank_mask:0x3
    v_dot2_f32_bf16 v144, v120, v32, 0
    v_dot2_f32_bf16 v145, v121, v33, 0
    v_add_f32_dpp v164, v166, v166 row_ror:8 row_mask:0xf bank_mask:0xc
    v_dot2_f32_bf16 v146, v122, v34, 0
    v_dot2_f32_bf16 v147, v123, v35, 0
    v_cvt_f32_i32 v136, v88
    v_cvt_f32_i32 v137, v89
    v_cvt_f32_i32 v138, v90
    v_cvt_f32_i32 v139, v91
    v_pk_add_f32 v[136:137], v[136:137], s[92:93]
    v_pk_add_f32 v[138:139], v[138:139], s[92:93]
    v_pk_mul_f32 v[152:153], v[136:137], v[144:145]
    v_pk_fma_f32 v[152:153], v[138:139], v[146:147], v[152:153]
    v_add_f32 v168, v152, v153
    buffer_load_dwordx4 v[52:55], v10, s[32:35], s51 offen offset:3072 nt
    s_waitcnt vmcnt(6)
    v_dot2_f32_bf16 v148, v124, v32, 0
    v_dot2_f32_bf16 v149, v125, v33, 0
    v_dot2_f32_bf16 v150, v126, v34, 0
    v_dot2_f32_bf16 v151, v127, v35, 0
    v_cvt_f32_i32 v140, v92
    v_cvt_f32_i32 v141, v93
    v_cvt_f32_i32 v142, v94
    v_cvt_f32_i32 v143, v95
    v_pk_add_f32 v[140:141], v[140:141], s[92:93]
    v_pk_add_f32 v[142:143], v[142:143], s[92:93]
    v_pk_mul_f32 v[154:155], v[140:141], v[148:149]
    v_pk_fma_f32 v[154:155], v[142:143], v[150:151], v[154:155]
    v_add_f32 v169, v154, v155
    buffer_load_dwordx4 v[56:59], v11, s[32:35], s51 offen offset:0 nt
    s_waitcnt vmcnt(6)
    v_permlane16_swap_b32 v168, v169
    v_add_f32 v168, v168, v169
    v_dot2_f32_bf16 v144, v128, v32, 0
    v_dot2_f32_bf16 v145, v129, v33, 0
    v_dot2_f32_bf16 v146, v130, v34, 0
    v_dot2_f32_bf16 v147, v131, v35, 0
    v_cvt_f32_i32 v136, v96
    v_cvt_f32_i32 v137, v97
    v_cvt_f32_i32 v138, v98
    v_cvt_f32_i32 v139, v99
    v_pk_add_f32 v[136:137], v[136:137], s[92:93]
    v_pk_add_f32 v[138:139], v[138:139], s[92:93]
    v_pk_mul_f32 v[152:153], v[136:137], v[144:145]
    v_pk_fma_f32 v[152:153], v[138:139], v[146:147], v[152:153]
    v_add_f32 v170, v152, v153
    buffer_load_dwordx4 v[60:63], v11, s[32:35], s51 offen offset:1024 nt
    s_waitcnt vmcnt(6)
    v_dot2_f32_bf16 v148, v132, v32, 0
    v_dot2_f32_bf16 v149, v133, v33, 0
    v_dot2_f32_bf16 v150, v134, v34, 0
    v_dot2_f32_bf16 v151, v135, v35, 0
    v_cvt_f32_i32 v140, v100
    v_cvt_f32_i32 v141, v101
    v_cvt_f32_i32 v142, v102
    v_cvt_f32_i32 v143, v103
    v_pk_add_f32 v[140:141], v[140:141], s[92:93]
    v_pk_add_f32 v[142:143], v[142:143], s[92:93]
    v_pk_mul_f32 v[154:155], v[140:141], v[148:149]
    v_pk_fma_f32 v[154:155], v[142:143], v[150:151], v[154:155]
    v_add_f32 v171, v154, v155
    s_nop 1
    v_permlane16_swap_b32 v170, v171
    v_add_f32 v170, v170, v171
    v_add_f32_dpp v168, v168, v168 row_ror:8 row_mask:0xf bank_mask:0x3
    s_nop 1
    v_add_f32_dpp v168, v170, v170 row_ror:8 row_mask:0xf bank_mask:0xc
    v_add_f32_dpp v164, v164, v164 row_half_mirror row_mask:0xf bank_mask:0x5
    s_nop 1
    v_add_f32_dpp v164, v168, v168 row_half_mirror row_mask:0xf bank_mask:0xa
    s_nop 1
    v_add_f32_dpp v164, v164, v164 quad_perm:[2,3,0,1] row_mask:0xf bank_mask:0xf
    s_nop 1
    v_add_f32_dpp v164, v164, v164 quad_perm:[1,0,3,2] row_mask:0xf bank_mask:0xf
    ds_write_b32 v37, v164 offset:1024
    v_add_u32 v36, 16, v36
    v_add_u32 v37, 32, v37
    v_add_f32 v232, 0x42000000, v232
    s_add_u32 s51, s51, 16384
    s_sub_u32 s53, s53, 1
    s_cmp_lg_u32 s53, 0
    s_cbranch_scc1 L_kloop
    buffer_load_dwordx4 v[64:67], v7, s[32:35], s51 offen offset:2048 nt
    v_pk_mul_f32 v[236:237], v[228:229], v[232:233] op_sel_hi:[1,0]
    v_pk_mul_f32 v[240:241], v[236:237], s[40:41]
    v_pk_fma_f32 v[244:245], v[236:237], s[40:41], v[240:241] neg_lo:[0,0,1] neg_hi:[0,0,1]
    v_pk_fma_f32 v[244:245], v[236:237], s[42:43], v[244:245]
    v_fract_f32 v240, v240
    v_fract_f32 v241, v241
    v_pk_add_f32 v[240:241], v[240:241], v[244:245]
    v_cos_f32 v236, v240
    v_cos_f32 v237, v241
    v_sin_f32 v240, v240
    v_sin_f32 v241, v241
    v_pk_mul_f32 v[238:239], v[230:231], v[232:233] op_sel_hi:[1,0]
    v_pk_mul_f32 v[242:243], v[238:239], s[40:41]
    v_pk_fma_f32 v[244:245], v[238:239], s[40:41], v[242:243] neg_lo:[0,0,1] neg_hi:[0,0,1]
    v_pk_fma_f32 v[244:245], v[238:239], s[42:43], v[244:245]
    v_fract_f32 v242, v242
    v_fract_f32 v243, v243
    v_pk_add_f32 v[242:243], v[242:243], v[244:245]
    v_cos_f32 v238, v242
    v_cos_f32 v239, v243
    v_sin_f32 v242, v242
    v_sin_f32 v243, v243
    v_cvt_pk_bf16_f32 v120, v236, v240
    v_cvt_pk_bf16_f32 v121, v237, v241
    v_cvt_pk_bf16_f32 v122, v238, v242
    v_cvt_pk_bf16_f32 v123, v239, v243
    s_waitcnt vmcnt(6)
    v_dot2_f32_bf16 v144, v120, v20, 0
    v_dot2_f32_bf16 v145, v121, v21, 0
    v_dot2_f32_bf16 v146, v122, v22, 0
    v_dot2_f32_bf16 v147, v123, v23, 0
    v_cvt_f32_i32 v136, v40
    v_cvt_f32_i32 v137, v41
    v_cvt_f32_i32 v138, v42
    v_cvt_f32_i32 v139, v43
    v_pk_add_f32 v[136:137], v[136:137], s[92:93]
    v_pk_add_f32 v[138:139], v[138:139], s[92:93]
    v_pk_mul_f32 v[152:153], v[136:137], v[144:145]
    v_pk_fma_f32 v[152:153], v[138:139], v[146:147], v[152:153]
    v_add_f32 v156, v152, v153
    buffer_load_dwordx4 v[68:71], v7, s[32:35], s51 offen offset:3072 nt
    v_add_f32 v234, 0x40000000, v232
    v_pk_mul_f32 v[236:237], v[228:229], v[234:235] op_sel_hi:[1,0]
    v_pk_mul_f32 v[240:241], v[236:237], s[40:41]
    v_pk_fma_f32 v[244:245], v[236:237], s[40:41], v[240:241] neg_lo:[0,0,1] neg_hi:[0,0,1]
    v_pk_fma_f32 v[244:245], v[236:237], s[42:43], v[244:245]
    v_fract_f32 v240, v240
    v_fract_f32 v241, v241
    v_pk_add_f32 v[240:241], v[240:241], v[244:245]
    v_cos_f32 v236, v240
    v_cos_f32 v237, v241
    v_sin_f32 v240, v240
    v_sin_f32 v241, v241
    v_pk_mul_f32 v[238:239], v[230:231], v[234:235] op_sel_hi:[1,0]
    v_pk_mul_f32 v[242:243], v[238:239], s[40:41]
    v_pk_fma_f32 v[244:245], v[238:239], s[40:41], v[242:243] neg_lo:[0,0,1] neg_hi:[0,0,1]
    v_pk_fma_f32 v[244:245], v[238:239], s[42:43], v[244:245]
    v_fract_f32 v242, v242
    v_fract_f32 v243, v243
    v_pk_add_f32 v[242:243], v[242:243], v[244:245]
    v_cos_f32 v238, v242
    v_cos_f32 v239, v243
    v_sin_f32 v242, v242
    v_sin_f32 v243, v243
    v_cvt_pk_bf16_f32 v124, v236, v240
    v_cvt_pk_bf16_f32 v125, v237, v241
    v_cvt_pk_bf16_f32 v126, v238, v242
    v_cvt_pk_bf16_f32 v127, v239, v243
    s_waitcnt vmcnt(6)
    v_dot2_f32_bf16 v148, v124, v20, 0
    v_dot2_f32_bf16 v149, v125, v21, 0
    v_dot2_f32_bf16 v150, v126, v22, 0
    v_dot2_f32_bf16 v151, v127, v23, 0
    v_cvt_f32_i32 v140, v44
    v_cvt_f32_i32 v141, v45
    v_cvt_f32_i32 v142, v46
    v_cvt_f32_i32 v143, v47
    v_pk_add_f32 v[140:141], v[140:141], s[92:93]
    v_pk_add_f32 v[142:143], v[142:143], s[92:93]
    v_pk_mul_f32 v[154:155], v[140:141], v[148:149]
    v_pk_fma_f32 v[154:155], v[142:143], v[150:151], v[154:155]
    v_add_f32 v157, v154, v155
    buffer_load_dwordx4 v[72:75], v8, s[32:35], s51 offen offset:0 nt
    v_add_f32 v234, 0x40800000, v232
    v_permlane16_swap_b32 v156, v157
    v_add_f32 v156, v156, v157
    v_pk_mul_f32 v[236:237], v[228:229], v[234:235] op_sel_hi:[1,0]
    v_pk_mul_f32 v[240:241], v[236:237], s[40:41]
    v_pk_fma_f32 v[244:245], v[236:237], s[40:41], v[240:241] neg_lo:[0,0,1] neg_hi:[0,0,1]
    v_pk_fma_f32 v[244:245], v[236:237], s[42:43], v[244:245]
    v_fract_f32 v240, v240
    v_fract_f32 v241, v241
    v_pk_add_f32 v[240:241], v[240:241], v[244:245]
    v_cos_f32 v236, v240
    v_cos_f32 v237, v241
    v_sin_f32 v240, v240
    v_sin_f32 v241, v241
    v_pk_mul_f32 v[238:239], v[230:231], v[234:235] op_sel_hi:[1,0]
    v_pk_mul_f32 v[242:243], v[238:239], s[40:41]
    v_pk_fma_f32 v[244:245], v[238:239], s[40:41], v[242:243] neg_lo:[0,0,1] neg_hi:[0,0,1]
    v_pk_fma_f32 v[244:245], v[238:239], s[42:43], v[244:245]
    v_fract_f32 v242, v242
    v_fract_f32 v243, v243
    v_pk_add_f32 v[242:243], v[242:243], v[244:245]
    v_cos_f32 v238, v242
    v_cos_f32 v239, v243
    v_sin_f32 v242, v242
    v_sin_f32 v243, v243
    v_cvt_pk_bf16_f32 v128, v236, v240
    v_cvt_pk_bf16_f32 v129, v237, v241
    v_cvt_pk_bf16_f32 v130, v238, v242
    v_cvt_pk_bf16_f32 v131, v239, v243
    s_waitcnt vmcnt(6)
    v_dot2_f32_bf16 v144, v128, v20, 0
    v_dot2_f32_bf16 v145, v129, v21, 0
    v_dot2_f32_bf16 v146, v130, v22, 0
    v_dot2_f32_bf16 v147, v131, v23, 0
    v_cvt_f32_i32 v136, v48
    v_cvt_f32_i32 v137, v49
    v_cvt_f32_i32 v138, v50
    v_cvt_f32_i32 v139, v51
    v_pk_add_f32 v[136:137], v[136:137], s[92:93]
    v_pk_add_f32 v[138:139], v[138:139], s[92:93]
    v_pk_mul_f32 v[152:153], v[136:137], v[144:145]
    v_pk_fma_f32 v[152:153], v[138:139], v[146:147], v[152:153]
    v_add_f32 v158, v152, v153
    buffer_load_dwordx4 v[76:79], v8, s[32:35], s51 offen offset:1024 nt
    v_add_f32 v234, 0x40c00000, v232
    v_pk_mul_f32 v[236:237], v[228:229], v[234:235] op_sel_hi:[1,0]
    v_pk_mul_f32 v[240:241], v[236:237], s[40:41]
    v_pk_fma_f32 v[244:245], v[236:237], s[40:41], v[240:241] neg_lo:[0,0,1] neg_hi:[0,0,1]
    v_pk_fma_f32 v[244:245], v[236:237], s[42:43], v[244:245]
    v_fract_f32 v240, v240
    v_fract_f32 v241, v241
    v_pk_add_f32 v[240:241], v[240:241], v[244:245]
    v_cos_f32 v236, v240
    v_cos_f32 v237, v241
    v_sin_f32 v240, v240
    v_sin_f32 v241, v241
    v_pk_mul_f32 v[238:239], v[230:231], v[234:235] op_sel_hi:[1,0]
    v_pk_mul_f32 v[242:243], v[238:239], s[40:41]
    v_pk_fma_f32 v[244:245], v[238:239], s[40:41], v[242:243] neg_lo:[0,0,1] neg_hi:[0,0,1]
    v_pk_fma_f32 v[244:245], v[238:239], s[42:43], v[244:245]
    v_fract_f32 v242, v242
    v_fract_f32 v243, v243
    v_pk_add_f32 v[242:243], v[242:243], v[244:245]
    v_cos_f32 v238, v242
    v_cos_f32 v239, v243
    v_sin_f32 v242, v242
    v_sin_f32 v243, v243
    v_cvt_pk_bf16_f32 v132, v236, v240
    v_cvt_pk_bf16_f32 v133, v237, v241
    v_cvt_pk_bf16_f32 v134, v238, v242
    v_cvt_pk_bf16_f32 v135, v239, v243
    s_waitcnt vmcnt(6)
    v_dot2_f32_bf16 v148, v132, v20, 0
    v_dot2_f32_bf16 v149, v133, v21, 0
    v_dot2_f32_bf16 v150, v134, v22, 0
    v_dot2_f32_bf16 v151, v135, v23, 0
    v_cvt_f32_i32 v140, v52
    v_cvt_f32_i32 v141, v53
    v_cvt_f32_i32 v142, v54
    v_cvt_f32_i32 v143, v55
    v_pk_add_f32 v[140:141], v[140:141], s[92:93]
    v_pk_add_f32 v[142:143], v[142:143], s[92:93]
    v_pk_mul_f32 v[154:155], v[140:141], v[148:149]
    v_pk_fma_f32 v[154:155], v[142:143], v[150:151], v[154:155]
    v_add_f32 v159, v154, v155
    buffer_load_dwordx4 v[80:83], v8, s[32:35], s51 offen offset:2048 nt
    s_waitcnt vmcnt(6)
    v_permlane16_swap_b32 v158, v159
    v_add_f32 v158, v158, v159
    v_add_f32_dpp v156, v156, v156 row_ror:8 row_mask:0xf bank_mask:0x3
    v_dot2_f32_bf16 v144, v120, v24, 0
    v_dot2_f32_bf16 v145, v121, v25, 0
    v_add_f32_dpp v156, v158, v158 row_ror:8 row_mask:0xf bank_mask:0xc
    v_dot2_f32_bf16 v146, v122, v26, 0
    v_dot2_f32_bf16 v147, v123, v27, 0
    v_cvt_f32_i32 v136, v56
    v_cvt_f32_i32 v137, v57
    v_cvt_f32_i32 v138, v58
    v_cvt_f32_i32 v139, v59
    v_pk_add_f32 v[136:137], v[136:137], s[92:93]
    v_pk_add_f32 v[138:139], v[138:139], s[92:93]
    v_pk_mul_f32 v[152:153], v[136:137], v[144:145]
    v_pk_fma_f32 v[152:153], v[138:139], v[146:147], v[152:153]
    v_add_f32 v160, v152, v153
    buffer_load_dwordx4 v[84:87], v8, s[32:35], s51 offen offset:3072 nt
    s_waitcnt vmcnt(6)
    v_dot2_f32_bf16 v148, v124, v24, 0
    v_dot2_f32_bf16 v149, v125, v25, 0
    v_dot2_f32_bf16 v150, v126, v26, 0
    v_dot2_f32_bf16 v151, v127, v27, 0
    v_cvt_f32_i32 v140, v60
    v_cvt_f32_i32 v141, v61
    v_cvt_f32_i32 v142, v62
    v_cvt_f32_i32 v143, v63
    v_pk_add_f32 v[140:141], v[140:141], s[92:93]
    v_pk_add_f32 v[142:143], v[142:143], s[92:93]
    v_pk_mul_f32 v[154:155], v[140:141], v[148:149]
    v_pk_fma_f32 v[154:155], v[142:143], v[150:151], v[154:155]
    v_add_f32 v161, v154, v155
    buffer_load_dwordx4 v[88:91], v9, s[32:35], s51 offen offset:0 nt
    s_waitcnt vmcnt(6)
    v_permlane16_swap_b32 v160, v161
    v_add_f32 v160, v160, v161
    v_dot2_f32_bf16 v144, v128, v24, 0
    v_dot2_f32_bf16 v145, v129, v25, 0
    v_dot2_f32_bf16 v146, v130, v26, 0
    v_dot2_f32_bf16 v147, v131, v27, 0
    v_cvt_f32_i32 v136, v64
    v_cvt_f32_i32 v137, v65
    v_cvt_f32_i32 v138, v66
    v_cvt_f32_i32 v139, v67
    v_pk_add_f32 v[136:137], v[136:137], s[92:93]
    v_pk_add_f32 v[138:139], v[138:139], s[92:93]
    v_pk_mul_f32 v[152:153], v[136:137], v[144:145]
    v_pk_fma_f32 v[152:153], v[138:139], v[146:147], v[152:153]
    v_add_f32 v162, v152, v153
    buffer_load_dwordx4 v[92:95], v9, s[32:35], s51 offen offset:1024 nt
    s_waitcnt vmcnt(6)
    v_dot2_f32_bf16 v148, v132, v24, 0
    v_dot2_f32_bf16 v149, v133, v25, 0
    v_dot2_f32_bf16 v150, v134, v26, 0
    v_dot2_f32_bf16 v151, v135, v27, 0
    v_cvt_f32_i32 v140, v68
    v_cvt_f32_i32 v141, v69
    v_cvt_f32_i32 v142, v70
    v_cvt_f32_i32 v143, v71
    v_pk_add_f32 v[140:141], v[140:141], s[92:93]
    v_pk_add_f32 v[142:143], v[142:143], s[92:93]
    v_pk_mul_f32 v[154:155], v[140:141], v[148:149]
    v_pk_fma_f32 v[154:155], v[142:143], v[150:151], v[154:155]
    v_add_f32 v163, v154, v155
    buffer_load_dwordx4 v[96:99], v9, s[32:35], s51 offen offset:2048 nt
    s_waitcnt vmcnt(6)
    v_permlane16_swap_b32 v162, v163
    v_add_f32 v162, v162, v163
    v_add_f32_dpp v160, v160, v160 row_ror:8 row_mask:0xf bank_mask:0x3
    v_dot2_f32_bf16 v144, v120, v28, 0
    v_dot2_f32_bf16 v145, v121, v29, 0
    v_add_f32_dpp v160, v162, v162 row_ror:8 row_mask:0xf bank_mask:0xc
    v_add_f32_dpp v156, v156, v156 row_half_mirror row_mask:0xf bank_mask:0x5
    v_dot2_f32_bf16 v146, v122, v30, 0
    v_dot2_f32_bf16 v147, v123, v31, 0
    v_add_f32_dpp v156, v160, v160 row_half_mirror row_mask:0xf bank_mask:0xa
    v_cvt_f32_i32 v136, v72
    v_cvt_f32_i32 v137, v73
    v_add_f32_dpp v156, v156, v156 quad_perm:[2,3,0,1] row_mask:0xf bank_mask:0xf
    v_cvt_f32_i32 v138, v74
    v_cvt_f32_i32 v139, v75
    v_add_f32_dpp v156, v156, v156 quad_perm:[1,0,3,2] row_mask:0xf bank_mask:0xf
    ds_write_b32 v37, v156 offset:0
    v_pk_add_f32 v[136:137], v[136:137], s[92:93]
    v_pk_add_f32 v[138:139], v[138:139], s[92:93]
    v_pk_mul_f32 v[152:153], v[136:137], v[144:145]
    v_pk_fma_f32 v[152:153], v[138:139], v[146:147], v[152:153]
    v_add_f32 v164, v152, v153
    buffer_load_dwordx4 v[100:103], v9, s[32:35], s51 offen offset:3072 nt
    s_waitcnt vmcnt(6)
    v_dot2_f32_bf16 v148, v124, v28, 0
    v_dot2_f32_bf16 v149, v125, v29, 0
    v_dot2_f32_bf16 v150, v126, v30, 0
    v_dot2_f32_bf16 v151, v127, v31, 0
    v_cvt_f32_i32 v140, v76
    v_cvt_f32_i32 v141, v77
    v_cvt_f32_i32 v142, v78
    v_cvt_f32_i32 v143, v79
    v_pk_add_f32 v[140:141], v[140:141], s[92:93]
    v_pk_add_f32 v[142:143], v[142:143], s[92:93]
    v_pk_mul_f32 v[154:155], v[140:141], v[148:149]
    v_pk_fma_f32 v[154:155], v[142:143], v[150:151], v[154:155]
    v_add_f32 v165, v154, v155
    buffer_load_dwordx4 v[40:43], v6, s[36:39], s58 offen offset:0 nt
    s_waitcnt vmcnt(6)
    v_permlane16_swap_b32 v164, v165
    v_add_f32 v164, v164, v165
    v_dot2_f32_bf16 v144, v128, v28, 0
    v_dot2_f32_bf16 v145, v129, v29, 0
    v_dot2_f32_bf16 v146, v130, v30, 0
    v_dot2_f32_bf16 v147, v131, v31, 0
    v_cvt_f32_i32 v136, v80
    v_cvt_f32_i32 v137, v81
    v_cvt_f32_i32 v138, v82
    v_cvt_f32_i32 v139, v83
    v_pk_add_f32 v[136:137], v[136:137], s[92:93]
    v_pk_add_f32 v[138:139], v[138:139], s[92:93]
    v_pk_mul_f32 v[152:153], v[136:137], v[144:145]
    v_pk_fma_f32 v[152:153], v[138:139], v[146:147], v[152:153]
    v_add_f32 v166, v152, v153
    buffer_load_dwordx4 v[44:47], v6, s[36:39], s58 offen offset:1024 nt
    s_waitcnt vmcnt(6)
    v_dot2_f32_bf16 v148, v132, v28, 0
    v_dot2_f32_bf16 v149, v133, v29, 0
    v_dot2_f32_bf16 v150, v134, v30, 0
    v_dot2_f32_bf16 v151, v135, v31, 0
    v_cvt_f32_i32 v140, v84
    v_cvt_f32_i32 v141, v85
    v_cvt_f32_i32 v142, v86
    v_cvt_f32_i32 v143, v87
    v_pk_add_f32 v[140:141], v[140:141], s[92:93]
    v_pk_add_f32 v[142:143], v[142:143], s[92:93]
    v_pk_mul_f32 v[154:155], v[140:141], v[148:149]
    v_pk_fma_f32 v[154:155], v[142:143], v[150:151], v[154:155]
    v_add_f32 v167, v154, v155
    buffer_load_dwordx4 v[48:51], v6, s[36:39], s58 offen offset:2048 nt
    s_waitcnt vmcnt(6)
    v_permlane16_swap_b32 v166, v167
    v_add_f32 v166, v166, v167
    v_add_f32_dpp v164, v164, v164 row_ror:8 row_mask:0xf bank_mask:0x3
    v_dot2_f32_bf16 v144, v120, v32, 0
    v_dot2_f32_bf16 v145, v121, v33, 0
    v_add_f32_dpp v164, v166, v166 row_ror:8 row_mask:0xf bank_mask:0xc
    v_dot2_f32_bf16 v146, v122, v34, 0
    v_dot2_f32_bf16 v147, v123, v35, 0
    v_cvt_f32_i32 v136, v88
    v_cvt_f32_i32 v137, v89
    v_cvt_f32_i32 v138, v90
    v_cvt_f32_i32 v139, v91
    v_pk_add_f32 v[136:137], v[136:137], s[92:93]
    v_pk_add_f32 v[138:139], v[138:139], s[92:93]
    v_pk_mul_f32 v[152:153], v[136:137], v[144:145]
    v_pk_fma_f32 v[152:153], v[138:139], v[146:147], v[152:153]
    v_add_f32 v168, v152, v153
    buffer_load_dwordx4 v[52:55], v6, s[36:39], s58 offen offset:3072 nt
    s_waitcnt vmcnt(6)
    v_dot2_f32_bf16 v148, v124, v32, 0
    v_dot2_f32_bf16 v149, v125, v33, 0
    v_dot2_f32_bf16 v150, v126, v34, 0
    v_dot2_f32_bf16 v151, v127, v35, 0
    v_cvt_f32_i32 v140, v92
    v_cvt_f32_i32 v141, v93
    v_cvt_f32_i32 v142, v94
    v_cvt_f32_i32 v143, v95
    v_pk_add_f32 v[140:141], v[140:141], s[92:93]
    v_pk_add_f32 v[142:143], v[142:143], s[92:93]
    v_pk_mul_f32 v[154:155], v[140:141], v[148:149]
    v_pk_fma_f32 v[154:155], v[142:143], v[150:151], v[154:155]
    v_add_f32 v169, v154, v155
    buffer_load_dwordx4 v[56:59], v7, s[36:39], s58 offen offset:0 nt
    s_waitcnt vmcnt(6)
    v_permlane16_swap_b32 v168, v169
    v_add_f32 v168, v168, v169
    v_dot2_f32_bf16 v144, v128, v32, 0
    v_dot2_f32_bf16 v145, v129, v33, 0
    v_dot2_f32_bf16 v146, v130, v34, 0
    v_dot2_f32_bf16 v147, v131, v35, 0
    v_cvt_f32_i32 v136, v96
    v_cvt_f32_i32 v137, v97
    v_cvt_f32_i32 v138, v98
    v_cvt_f32_i32 v139, v99
    v_pk_add_f32 v[136:137], v[136:137], s[92:93]
    v_pk_add_f32 v[138:139], v[138:139], s[92:93]
    v_pk_mul_f32 v[152:153], v[136:137], v[144:145]
    v_pk_fma_f32 v[152:153], v[138:139], v[146:147], v[152:153]
    v_add_f32 v170, v152, v153
    buffer_load_dwordx4 v[60:63], v7, s[36:39], s58 offen offset:1024 nt
    s_waitcnt vmcnt(6)
    v_dot2_f32_bf16 v148, v132, v32, 0
    v_dot2_f32_bf16 v149, v133, v33, 0
    v_dot2_f32_bf16 v150, v134, v34, 0
    v_dot2_f32_bf16 v151, v135, v35, 0
    v_cvt_f32_i32 v140, v100
    v_cvt_f32_i32 v141, v101
    v_cvt_f32_i32 v142, v102
    v_cvt_f32_i32 v143, v103
    v_pk_add_f32 v[140:141], v[140:141], s[92:93]
    v_pk_add_f32 v[142:143], v[142:143], s[92:93]
    v_pk_mul_f32 v[154:155], v[140:141], v[148:149]
    v_pk_fma_f32 v[154:155], v[142:143], v[150:151], v[154:155]
    v_add_f32 v171, v154, v155
    s_nop 1
    v_permlane16_swap_b32 v170, v171
    v_add_f32 v170, v170, v171
    v_add_f32_dpp v168, v168, v168 row_ror:8 row_mask:0xf bank_mask:0x3
    s_nop 1
    v_add_f32_dpp v168, v170, v170 row_ror:8 row_mask:0xf bank_mask:0xc
    v_add_f32_dpp v164, v164, v164 row_half_mirror row_mask:0xf bank_mask:0x5
    s_nop 1
    v_add_f32_dpp v164, v168, v168 row_half_mirror row_mask:0xf bank_mask:0xa
    s_nop 1
    v_add_f32_dpp v164, v164, v164 quad_perm:[2,3,0,1] row_mask:0xf bank_mask:0xf
    s_nop 1
    v_add_f32_dpp v164, v164, v164 quad_perm:[1,0,3,2] row_mask:0xf bank_mask:0xf
    ds_write_b32 v37, v164 offset:1024
    ds_read_b128 v[136:139], v39 offset:0
    ds_read_b128 v[140:143], v39 offset:16
    v_lshlrev_b32 v144, 16, v204
    v_and_b32 v145, 0xffff0000, v204
    v_lshlrev_b32 v146, 16, v205
    v_and_b32 v147, 0xffff0000, v205
    v_lshlrev_b32 v148, 16, v206
    v_and_b32 v149, 0xffff0000, v206
    v_lshlrev_b32 v150, 16, v207
    v_and_b32 v151, 0xffff0000, v207
    s_waitcnt lgkmcnt(0)
    v_pk_mul_f32 v[136:137], v[136:137], v[144:145]
    v_pk_mul_f32 v[138:139], v[138:139], v[146:147]
    v_pk_mul_f32 v[140:141], v[140:141], v[148:149]
    v_pk_mul_f32 v[142:143], v[142:143], v[150:151]
    v_max3_f32 v220, v136, v137, v138
    v_max3_f32 v220, v220, v139, v140
    v_max3_f32 v220, v220, v141, v142
    v_max_f32 v220, v220, v143
    s_nop 1
    v_max_f32_dpp v220, v220, v220 quad_perm:[1,0,3,2] row_mask:0xf bank_mask:0xf
    s_nop 1
    v_max_f32_dpp v220, v220, v220 quad_perm:[2,3,0,1] row_mask:0xf bank_mask:0xf
    s_nop 1
    v_max_f32_dpp v220, v220, v220 row_half_mirror row_mask:0xf bank_mask:0xf
    s_nop 1
    v_max_f32_dpp v220, v220, v220 row_mirror row_mask:0xf bank_mask:0xf
    v_mul_f32 v220, s59, v220
    v_fma_f32 v136, v136, s59, -v220
    v_fma_f32 v137, v137, s59, -v220
    v_fma_f32 v138, v138, s59, -v220
    v_fma_f32 v139, v139, s59, -v220
    v_fma_f32 v140, v140, s59, -v220
    v_fma_f32 v141, v141, s59, -v220
    v_fma_f32 v142, v142, s59, -v220
    v_fma_f32 v143, v143, s59, -v220
    v_exp_f32 v136, v136
    v_exp_f32 v137, v137
    v_exp_f32 v138, v138
    v_exp_f32 v139, v139
    v_exp_f32 v140, v140
    v_exp_f32 v141, v141
    v_exp_f32 v142, v142
    v_exp_f32 v143, v143
    v_lshlrev_b32 v144, 16, v208
    v_and_b32 v145, 0xffff0000, v208
    v_lshlrev_b32 v146, 16, v209
    v_and_b32 v147, 0xffff0000, v209
    v_lshlrev_b32 v148, 16, v210
    v_and_b32 v149, 0xffff0000, v210
    v_lshlrev_b32 v150, 16, v211
    v_and_b32 v151, 0xffff0000, v211
    v_add_f32 v221, v136, v137
    v_add_f32 v221, v221, v138
    v_add_f32 v221, v221, v139
    v_add_f32 v221, v221, v140
    v_add_f32 v221, v221, v141
    v_add_f32 v221, v221, v142
    v_add_f32 v221, v221, v143
    v_pk_mul_f32 v[136:137], v[136:137], v[144:145]
    v_pk_mul_f32 v[138:139], v[138:139], v[146:147]
    v_pk_mul_f32 v[140:141], v[140:141], v[148:149]
    v_pk_mul_f32 v[142:143], v[142:143], v[150:151]
    v_mov_b32 v152, v136
    v_mov_b32 v156, v137
    v_mov_b32 v153, v138
    v_mov_b32 v157, v139
    v_mov_b32 v154, v140
    v_mov_b32 v158, v141
    v_mov_b32 v155, v142
    v_mov_b32 v159, v143
    ds_write_b128 v38, v[152:155]
    ds_write_b128 v38, v[156:159] offset:256
    v_add_f32 v222, v136, v137
    v_add_f32 v222, v222, v138
    v_add_f32 v222, v222, v139
    v_add_f32 v222, v222, v140
    v_add_f32 v222, v222, v141
    v_add_f32 v222, v222, v142
    v_add_f32 v222, v222, v143
    v_mul_f32 v222, 0x40f00000, v222
    v_add_f32_dpp v221, v221, v221 quad_perm:[1,0,3,2] row_mask:0xf bank_mask:0xf
    s_nop 1
    v_add_f32_dpp v221, v221, v221 quad_perm:[2,3,0,1] row_mask:0xf bank_mask:0xf
    s_nop 1
    v_add_f32_dpp v221, v221, v221 row_half_mirror row_mask:0xf bank_mask:0xf
    s_nop 1
    v_add_f32_dpp v221, v221, v221 row_mirror row_mask:0xf bank_mask:0xf
    v_add_f32_dpp v222, v222, v222 quad_perm:[1,0,3,2] row_mask:0xf bank_mask:0xf
    s_nop 1
    v_add_f32_dpp v222, v222, v222 quad_perm:[2,3,0,1] row_mask:0xf bank_mask:0xf
    s_nop 1
    v_add_f32_dpp v222, v222, v222 row_half_mirror row_mask:0xf bank_mask:0xf
    s_nop 1
    v_add_f32_dpp v222, v222, v222 row_mirror row_mask:0xf bank_mask:0xf
    v_subrev_u32 v36, 240, v36
    s_mul_i32 s56, s50, 4096
    s_add_u32 s56, s56, 16384
    v_add_u32 v20, s56, v4
    s_mul_i32 s56, s50, 64
    s_add_u32 s56, s56, 32768
    v_lshrrev_b32 v21, 4, v1
    v_lshl_add_u32 v21, v21, 4, s56
    s_lshl_b32 s56, s50, 4
    s_add_u32 s56, s56, 32768
    v_mov_b32 v22, s56
    s_lshl_b32 s56, s50, 10
    s_add_u32 s56, s56, 16384
    v_add_u32 v23, s56, v5
    s_mul_i32 s56, s48, 4
    s_add_u32 s57, s56, s50
    s_mul_i32 s56, s57, 16384
    v_add_u32 v30, s56, v4
    v_add_u32 v31, 0x1000, v30
    v_add_u32 v32, 0x2000, v30
    v_add_u32 v33, 0x3000, v30
    s_lshl_b32 s60, s49, 10
    v_add_u32 v24, s60, v30
    s_lshl_b32 s56, s57, 8
    v_lshlrev_b32 v25, 2, v1
    v_add_u32 v25, s56, v25
    v_mov_b32 v26, 33024
    s_lshl_b32 s56, s48, 2
    v_mov_b32 v27, s56
    v_mov_b32 v28, 1
    v_add_u32 v225, 1, v225
    s_mov_b32 s44, 0x10001
    s_mov_b32 s45, 0x10001
    s_mov_b32 s46, 0xaaaaaaaa
    s_mov_b32 s47, 0xaaaaaaaa
    s_mov_b32 s53, 15
    s_nop 4
L_vloop:
    ds_read_b128 v[172:175], v36 offset:0
    ds_read_b128 v[176:179], v36 offset:512
    ds_read_b128 v[180:183], v36 offset:1024
    ds_read_b128 v[184:187], v36 offset:1536
    buffer_load_dwordx4 v[64:67], v7, s[36:39], s58 offen offset:2048 nt
    s_waitcnt vmcnt(6) lgkmcnt(0)
    v_cvt_f32_i32 v136, v40
    v_cvt_f32_i32 v137, v41
    v_cvt_f32_i32 v138, v42
    v_cvt_f32_i32 v139, v43
    v_pk_fma_f32 v[188:189], v[136:137], v[172:173], v[188:189] op_sel_hi:[1,0,1]
    v_pk_fma_f32 v[190:191], v[138:139], v[172:173], v[190:191] op_sel_hi:[1,0,1]
    buffer_load_dwordx4 v[68:71], v7, s[36:39], s58 offen offset:3072 nt
    s_waitcnt vmcnt(6)
    v_cvt_f32_i32 v140, v44
    v_cvt_f32_i32 v141, v45
    v_cvt_f32_i32 v142, v46
    v_cvt_f32_i32 v143, v47
    v_pk_fma_f32 v[188:189], v[140:141], v[172:173], v[188:189] op_sel:[0,1,0] op_sel_hi:[1,1,1]
    v_pk_fma_f32 v[190:191], v[142:143], v[172:173], v[190:191] op_sel:[0,1,0] op_sel_hi:[1,1,1]
    buffer_load_dwordx4 v[72:75], v8, s[36:39], s58 offen offset:0 nt
    s_waitcnt vmcnt(6)
    v_cvt_f32_i32 v136, v48
    v_cvt_f32_i32 v137, v49
    v_cvt_f32_i32 v138, v50
    v_cvt_f32_i32 v139, v51
    v_pk_fma_f32 v[188:189], v[136:137], v[174:175], v[188:189] op_sel_hi:[1,0,1]
    v_pk_fma_f32 v[190:191], v[138:139], v[174:175], v[190:191] op_sel_hi:[1,0,1]
    buffer_load_dwordx4 v[76:79], v8, s[36:39], s58 offen offset:1024 nt
    s_waitcnt vmcnt(6)
    v_cvt_f32_i32 v140, v52
    v_cvt_f32_i32 v141, v53
    v_cvt_f32_i32 v142, v54
    v_cvt_f32_i32 v143, v55
    v_pk_fma_f32 v[188:189], v[140:141], v[174:175], v[188:189] op_sel:[0,1,0] op_sel_hi:[1,1,1]
    v_pk_fma_f32 v[190:191], v[142:143], v[174:175], v[190:191] op_sel:[0,1,0] op_sel_hi:[1,1,1]
    buffer_load_dwordx4 v[80:83], v8, s[36:39], s58 offen offset:2048 nt
    s_waitcnt vmcnt(6)
    v_cvt_f32_i32 v136, v56
    v_cvt_f32_i32 v137, v57
    v_cvt_f32_i32 v138, v58
    v_cvt_f32_i32 v139, v59
    v_pk_fma_f32 v[192:193], v[136:137], v[176:177], v[192:193] op_sel_hi:[1,0,1]
    v_pk_fma_f32 v[194:195], v[138:139], v[176:177], v[194:195] op_sel_hi:[1,0,1]
    buffer_load_dwordx4 v[84:87], v8, s[36:39], s58 offen offset:3072 nt
    s_waitcnt vmcnt(6)
    v_cvt_f32_i32 v140, v60
    v_cvt_f32_i32 v141, v61
    v_cvt_f32_i32 v142, v62
    v_cvt_f32_i32 v143, v63
    v_pk_fma_f32 v[192:193], v[140:141], v[176:177], v[192:193] op_sel:[0,1,0] op_sel_hi:[1,1,1]
    v_pk_fma_f32 v[194:195], v[142:143], v[176:177], v[194:195] op_sel:[0,1,0] op_sel_hi:[1,1,1]
    buffer_load_dwordx4 v[88:91], v9, s[36:39], s58 offen offset:0 nt
    s_waitcnt vmcnt(6)
    v_cvt_f32_i32 v136, v64
    v_cvt_f32_i32 v137, v65
    v_cvt_f32_i32 v138, v66
    v_cvt_f32_i32 v139, v67
    v_pk_fma_f32 v[192:193], v[136:137], v[178:179], v[192:193] op_sel_hi:[1,0,1]
    v_pk_fma_f32 v[194:195], v[138:139], v[178:179], v[194:195] op_sel_hi:[1,0,1]
    buffer_load_dwordx4 v[92:95], v9, s[36:39], s58 offen offset:1024 nt
    s_waitcnt vmcnt(6)
    v_cvt_f32_i32 v140, v68
    v_cvt_f32_i32 v141, v69
    v_cvt_f32_i32 v142, v70
    v_cvt_f32_i32 v143, v71
    v_pk_fma_f32 v[192:193], v[140:141], v[178:179], v[192:193] op_sel:[0,1,0] op_sel_hi:[1,1,1]
    v_pk_fma_f32 v[194:195], v[142:143], v[178:179], v[194:195] op_sel:[0,1,0] op_sel_hi:[1,1,1]
    buffer_load_dwordx4 v[96:99], v9, s[36:39], s58 offen offset:2048 nt
    s_waitcnt vmcnt(6)
    v_cvt_f32_i32 v136, v72
    v_cvt_f32_i32 v137, v73
    v_cvt_f32_i32 v138, v74
    v_cvt_f32_i32 v139, v75
    v_pk_fma_f32 v[196:197], v[136:137], v[180:181], v[196:197] op_sel_hi:[1,0,1]
    v_pk_fma_f32 v[198:199], v[138:139], v[180:181], v[198:199] op_sel_hi:[1,0,1]
    buffer_load_dwordx4 v[100:103], v9, s[36:39], s58 offen offset:3072 nt
    s_waitcnt vmcnt(6)
    v_cvt_f32_i32 v140, v76
    v_cvt_f32_i32 v141, v77
    v_cvt_f32_i32 v142, v78
    v_cvt_f32_i32 v143, v79
    v_pk_fma_f32 v[196:197], v[140:141], v[180:181], v[196:197] op_sel:[0,1,0] op_sel_hi:[1,1,1]
    v_pk_fma_f32 v[198:199], v[142:143], v[180:181], v[198:199] op_sel:[0,1,0] op_sel_hi:[1,1,1]
    buffer_load_dwordx4 v[40:43], v10, s[36:39], s58 offen offset:0 nt
    s_waitcnt vmcnt(6)
    v_cvt_f32_i32 v136, v80
    v_cvt_f32_i32 v137, v81
    v_cvt_f32_i32 v138, v82
    v_cvt_f32_i32 v139, v83
    v_pk_fma_f32 v[196:197], v[136:137], v[182:183], v[196:197] op_sel_hi:[1,0,1]
    v_pk_fma_f32 v[198:199], v[138:139], v[182:183], v[198:199] op_sel_hi:[1,0,1]
    buffer_load_dwordx4 v[44:47], v10, s[36:39], s58 offen offset:1024 nt
    s_waitcnt vmcnt(6)
    v_cvt_f32_i32 v140, v84
    v_cvt_f32_i32 v141, v85
    v_cvt_f32_i32 v142, v86
    v_cvt_f32_i32 v143, v87
    v_pk_fma_f32 v[196:197], v[140:141], v[182:183], v[196:197] op_sel:[0,1,0] op_sel_hi:[1,1,1]
    v_pk_fma_f32 v[198:199], v[142:143], v[182:183], v[198:199] op_sel:[0,1,0] op_sel_hi:[1,1,1]
    buffer_load_dwordx4 v[48:51], v10, s[36:39], s58 offen offset:2048 nt
    s_waitcnt vmcnt(6)
    v_cvt_f32_i32 v136, v88
    v_cvt_f32_i32 v137, v89
    v_cvt_f32_i32 v138, v90
    v_cvt_f32_i32 v139, v91
    v_pk_fma_f32 v[200:201], v[136:137], v[184:185], v[200:201] op_sel_hi:[1,0,1]
    v_pk_fma_f32 v[202:203], v[138:139], v[184:185], v[202:203] op_sel_hi:[1,0,1]
    buffer_load_dwordx4 v[52:55], v10, s[36:39], s58 offen offset:3072 nt
    s_waitcnt vmcnt(6)
    v_cvt_f32_i32 v140, v92
    v_cvt_f32_i32 v141, v93
    v_cvt_f32_i32 v142, v94
    v_cvt_f32_i32 v143, v95
    v_pk_fma_f32 v[200:201], v[140:141], v[184:185], v[200:201] op_sel:[0,1,0] op_sel_hi:[1,1,1]
    v_pk_fma_f32 v[202:203], v[142:143], v[184:185], v[202:203] op_sel:[0,1,0] op_sel_hi:[1,1,1]
    buffer_load_dwordx4 v[56:59], v11, s[36:39], s58 offen offset:0 nt
    s_waitcnt vmcnt(6)
    v_cvt_f32_i32 v136, v96
    v_cvt_f32_i32 v137, v97
    v_cvt_f32_i32 v138, v98
    v_cvt_f32_i32 v139, v99
    v_pk_fma_f32 v[200:201], v[136:137], v[186:187], v[200:201] op_sel_hi:[1,0,1]
    v_pk_fma_f32 v[202:203], v[138:139], v[186:187], v[202:203] op_sel_hi:[1,0,1]
    buffer_load_dwordx4 v[60:63], v11, s[36:39], s58 offen offset:1024 nt
    s_waitcnt vmcnt(6)
    v_cvt_f32_i32 v140, v100
    v_cvt_f32_i32 v141, v101
    v_cvt_f32_i32 v142, v102
    v_cvt_f32_i32 v143, v103
    v_pk_fma_f32 v[200:201], v[140:141], v[186:187], v[200:201] op_sel:[0,1,0] op_sel_hi:[1,1,1]
    v_pk_fma_f32 v[202:203], v[142:143], v[186:187], v[202:203] op_sel:[0,1,0] op_sel_hi:[1,1,1]
    v_add_u32 v36, 16, v36
    s_add_u32 s58, s58, 16384
    s_sub_u32 s53, s53, 1
    s_cmp_lg_u32 s53, 0
    s_cbranch_scc1 L_vloop
    ds_read_b128 v[172:175], v36 offset:0
    ds_read_b128 v[176:179], v36 offset:512
    ds_read_b128 v[180:183], v36 offset:1024
    ds_read_b128 v[184:187], v36 offset:1536
    buffer_load_dwordx4 v[64:67], v7, s[36:39], s58 offen offset:2048 nt
    s_waitcnt vmcnt(6) lgkmcnt(0)
    v_cvt_f32_i32 v136, v40
    v_cvt_f32_i32 v137, v41
    v_cvt_f32_i32 v138, v42
    v_cvt_f32_i32 v139, v43
    v_pk_fma_f32 v[188:189], v[136:137], v[172:173], v[188:189] op_sel_hi:[1,0,1]
    v_pk_fma_f32 v[190:191], v[138:139], v[172:173], v[190:191] op_sel_hi:[1,0,1]
    buffer_load_dwordx4 v[68:71], v7, s[36:39], s58 offen offset:3072 nt
    s_waitcnt vmcnt(6)
    v_cvt_f32_i32 v140, v44
    v_cvt_f32_i32 v141, v45
    v_cvt_f32_i32 v142, v46
    v_cvt_f32_i32 v143, v47
    v_pk_fma_f32 v[188:189], v[140:141], v[172:173], v[188:189] op_sel:[0,1,0] op_sel_hi:[1,1,1]
    v_pk_fma_f32 v[190:191], v[142:143], v[172:173], v[190:191] op_sel:[0,1,0] op_sel_hi:[1,1,1]
    buffer_load_dwordx4 v[72:75], v8, s[36:39], s58 offen offset:0 nt
    s_waitcnt vmcnt(6)
    v_cvt_f32_i32 v136, v48
    v_cvt_f32_i32 v137, v49
    v_cvt_f32_i32 v138, v50
    v_cvt_f32_i32 v139, v51
    v_pk_fma_f32 v[188:189], v[136:137], v[174:175], v[188:189] op_sel_hi:[1,0,1]
    v_pk_fma_f32 v[190:191], v[138:139], v[174:175], v[190:191] op_sel_hi:[1,0,1]
    buffer_load_dwordx4 v[76:79], v8, s[36:39], s58 offen offset:1024 nt
    s_waitcnt vmcnt(6)
    v_cvt_f32_i32 v140, v52
    v_cvt_f32_i32 v141, v53
    v_cvt_f32_i32 v142, v54
    v_cvt_f32_i32 v143, v55
    v_pk_fma_f32 v[188:189], v[140:141], v[174:175], v[188:189] op_sel:[0,1,0] op_sel_hi:[1,1,1]
    v_pk_fma_f32 v[190:191], v[142:143], v[174:175], v[190:191] op_sel:[0,1,0] op_sel_hi:[1,1,1]
    buffer_load_dwordx4 v[80:83], v8, s[36:39], s58 offen offset:2048 nt
    s_waitcnt vmcnt(6)
    v_cvt_f32_i32 v136, v56
    v_cvt_f32_i32 v137, v57
    v_cvt_f32_i32 v138, v58
    v_cvt_f32_i32 v139, v59
    v_pk_fma_f32 v[192:193], v[136:137], v[176:177], v[192:193] op_sel_hi:[1,0,1]
    v_pk_fma_f32 v[194:195], v[138:139], v[176:177], v[194:195] op_sel_hi:[1,0,1]
    buffer_load_dwordx4 v[84:87], v8, s[36:39], s58 offen offset:3072 nt
    s_waitcnt vmcnt(6)
    v_cvt_f32_i32 v140, v60
    v_cvt_f32_i32 v141, v61
    v_cvt_f32_i32 v142, v62
    v_cvt_f32_i32 v143, v63
    v_pk_fma_f32 v[192:193], v[140:141], v[176:177], v[192:193] op_sel:[0,1,0] op_sel_hi:[1,1,1]
    v_pk_fma_f32 v[194:195], v[142:143], v[176:177], v[194:195] op_sel:[0,1,0] op_sel_hi:[1,1,1]
    buffer_load_dwordx4 v[88:91], v9, s[36:39], s58 offen offset:0 nt
    s_waitcnt vmcnt(6)
    v_cvt_f32_i32 v136, v64
    v_cvt_f32_i32 v137, v65
    v_cvt_f32_i32 v138, v66
    v_cvt_f32_i32 v139, v67
    v_pk_fma_f32 v[192:193], v[136:137], v[178:179], v[192:193] op_sel_hi:[1,0,1]
    v_pk_fma_f32 v[194:195], v[138:139], v[178:179], v[194:195] op_sel_hi:[1,0,1]
    buffer_load_dwordx4 v[92:95], v9, s[36:39], s58 offen offset:1024 nt
    s_waitcnt vmcnt(6)
    v_cvt_f32_i32 v140, v68
    v_cvt_f32_i32 v141, v69
    v_cvt_f32_i32 v142, v70
    v_cvt_f32_i32 v143, v71
    v_pk_fma_f32 v[192:193], v[140:141], v[178:179], v[192:193] op_sel:[0,1,0] op_sel_hi:[1,1,1]
    v_pk_fma_f32 v[194:195], v[142:143], v[178:179], v[194:195] op_sel:[0,1,0] op_sel_hi:[1,1,1]
    buffer_load_dwordx4 v[96:99], v9, s[36:39], s58 offen offset:2048 nt
    s_waitcnt vmcnt(6)
    v_cvt_f32_i32 v136, v72
    v_cvt_f32_i32 v137, v73
    v_cvt_f32_i32 v138, v74
    v_cvt_f32_i32 v139, v75
    v_pk_fma_f32 v[196:197], v[136:137], v[180:181], v[196:197] op_sel_hi:[1,0,1]
    v_pk_fma_f32 v[198:199], v[138:139], v[180:181], v[198:199] op_sel_hi:[1,0,1]
    buffer_load_dwordx4 v[100:103], v9, s[36:39], s58 offen offset:3072 nt
    s_waitcnt vmcnt(6)
    v_cvt_f32_i32 v140, v76
    v_cvt_f32_i32 v141, v77
    v_cvt_f32_i32 v142, v78
    v_cvt_f32_i32 v143, v79
    v_pk_fma_f32 v[196:197], v[140:141], v[180:181], v[196:197] op_sel:[0,1,0] op_sel_hi:[1,1,1]
    v_pk_fma_f32 v[198:199], v[142:143], v[180:181], v[198:199] op_sel:[0,1,0] op_sel_hi:[1,1,1]
    s_waitcnt vmcnt(5)
    v_cvt_f32_i32 v136, v80
    v_cvt_f32_i32 v137, v81
    v_cvt_f32_i32 v138, v82
    v_cvt_f32_i32 v139, v83
    v_pk_fma_f32 v[196:197], v[136:137], v[182:183], v[196:197] op_sel_hi:[1,0,1]
    v_pk_fma_f32 v[198:199], v[138:139], v[182:183], v[198:199] op_sel_hi:[1,0,1]
    s_waitcnt vmcnt(4)
    v_cvt_f32_i32 v140, v84
    v_cvt_f32_i32 v141, v85
    v_cvt_f32_i32 v142, v86
    v_cvt_f32_i32 v143, v87
    v_pk_fma_f32 v[196:197], v[140:141], v[182:183], v[196:197] op_sel:[0,1,0] op_sel_hi:[1,1,1]
    v_pk_fma_f32 v[198:199], v[142:143], v[182:183], v[198:199] op_sel:[0,1,0] op_sel_hi:[1,1,1]
    s_waitcnt vmcnt(3)
    v_cvt_f32_i32 v136, v88
    v_cvt_f32_i32 v137, v89
    v_cvt_f32_i32 v138, v90
    v_cvt_f32_i32 v139, v91
    v_pk_fma_f32 v[200:201], v[136:137], v[184:185], v[200:201] op_sel_hi:[1,0,1]
    v_pk_fma_f32 v[202:203], v[138:139], v[184:185], v[202:203] op_sel_hi:[1,0,1]
    s_waitcnt vmcnt(2)
    v_cvt_f32_i32 v140, v92
    v_cvt_f32_i32 v141, v93
    v_cvt_f32_i32 v142, v94
    v_cvt_f32_i32 v143, v95
    v_pk_fma_f32 v[200:201], v[140:141], v[184:185], v[200:201] op_sel:[0,1,0] op_sel_hi:[1,1,1]
    v_pk_fma_f32 v[202:203], v[142:143], v[184:185], v[202:203] op_sel:[0,1,0] op_sel_hi:[1,1,1]
    s_waitcnt vmcnt(1)
    v_cvt_f32_i32 v136, v96
    v_cvt_f32_i32 v137, v97
    v_cvt_f32_i32 v138, v98
    v_cvt_f32_i32 v139, v99
    v_pk_fma_f32 v[200:201], v[136:137], v[186:187], v[200:201] op_sel_hi:[1,0,1]
    v_pk_fma_f32 v[202:203], v[138:139], v[186:187], v[202:203] op_sel_hi:[1,0,1]
    s_waitcnt vmcnt(0)
    v_cvt_f32_i32 v140, v100
    v_cvt_f32_i32 v141, v101
    v_cvt_f32_i32 v142, v102
    v_cvt_f32_i32 v143, v103
    v_pk_fma_f32 v[200:201], v[140:141], v[186:187], v[200:201] op_sel:[0,1,0] op_sel_hi:[1,1,1]
    v_pk_fma_f32 v[202:203], v[142:143], v[186:187], v[202:203] op_sel:[0,1,0] op_sel_hi:[1,1,1]
    ds_write_b128 v20, v[188:191] offset:0
    ds_write_b128 v20, v[192:195] offset:1024
    ds_write_b128 v20, v[196:199] offset:2048
    ds_write_b128 v20, v[200:203] offset:3072
    s_mov_b64 exec, s[44:45]
    ds_write_b96 v21, v[220:222]
    s_mov_b64 exec, -1
    s_waitcnt lgkmcnt(0)
    s_barrier
    s_cmp_lg_u32 s50, 0
    s_cbranch_scc1 L_no_ticket
    s_mov_b64 exec, 1
    global_atomic_add v29, v27, v28, s[28:29] sc0
    s_mov_b64 exec, -1
L_no_ticket:
    ds_read_b96 v[40:42], v22 offset:0
    ds_read_b96 v[44:46], v22 offset:64
    ds_read_b96 v[48:50], v22 offset:128
    ds_read_b96 v[52:54], v22 offset:192
    ds_read_b64 v[56:57], v23 offset:0
    ds_read_b64 v[58:59], v23 offset:512
    ds_read_b64 v[60:61], v23 offset:4096
    ds_read_b64 v[62:63], v23 offset:4608
    ds_read_b64 v[64:65], v23 offset:8192
    ds_read_b64 v[66:67], v23 offset:8704
    ds_read_b64 v[68:69], v23 offset:12288
    ds_read_b64 v[70:71], v23 offset:12800
    s_waitcnt lgkmcnt(0)
    v_pk_add_f32 v[56:57], v[56:57], v[58:59]
    v_sub_f32 v56, v56, v42
    v_sub_f32 v57, v57, v42
    v_pk_add_f32 v[60:61], v[60:61], v[62:63]
    v_sub_f32 v60, v60, v46
    v_sub_f32 v61, v61, v46
    v_pk_add_f32 v[64:65], v[64:65], v[66:67]
    v_sub_f32 v64, v64, v50
    v_sub_f32 v65, v65, v50
    v_pk_add_f32 v[68:69], v[68:69], v[70:71]
    v_sub_f32 v68, v68, v54
    v_sub_f32 v69, v69, v54
    v_max3_f32 v206, v40, v44, v48
    v_max_f32 v206, v206, v52
    v_sub_f32 v40, v40, v206
    v_sub_f32 v44, v44, v206
    v_sub_f32 v48, v48, v206
    v_sub_f32 v52, v52, v206
    v_exp_f32 v40, v40
    v_exp_f32 v44, v44
    v_exp_f32 v48, v48
    v_exp_f32 v52, v52
    v_mul_f32 v207, v40, v41
    v_mul_f32 v204, v40, v56
    v_mul_f32 v205, v40, v57
    v_fmac_f32 v207, v44, v45
    v_fmac_f32 v204, v44, v60
    v_fmac_f32 v205, v44, v61
    v_fmac_f32 v207, v48, v49
    v_fmac_f32 v204, v48, v64
    v_fmac_f32 v205, v48, v65
    v_fmac_f32 v207, v52, v53
    v_fmac_f32 v204, v52, v68
    v_fmac_f32 v205, v52, v69
    v_cndmask_b32 v206, v206, v207, s[46:47]
    v_mov_b32 v207, v225
    global_store_dwordx4 v24, v[204:207], s[30:31] sc0 sc1
    s_cmp_lg_u32 s50, 0
    s_cbranch_scc1 L_wait_ticket
    s_waitcnt vmcnt(1)
    s_mov_b64 exec, 1
    ds_write_b32 v26, v29
    s_waitcnt lgkmcnt(0)
    s_mov_b64 exec, -1
L_wait_ticket:
    s_barrier
    ds_read_b32 v29, v26
    s_waitcnt lgkmcnt(0)
    v_readfirstlane_b32 s56, v29
    s_nop 3
    s_cmp_lg_u32 s56, 15
    s_cbranch_scc1 L_end
    s_mov_b32 s53, 8192
    s_nop 4
L_poll:
    global_load_dwordx4 v[40:43], v30, s[30:31] offset:0 sc0 sc1
    global_load_dwordx4 v[44:47], v30, s[30:31] offset:1024 sc0 sc1
    global_load_dwordx4 v[48:51], v30, s[30:31] offset:2048 sc0 sc1
    global_load_dwordx4 v[52:55], v30, s[30:31] offset:3072 sc0 sc1
    global_load_dwordx4 v[56:59], v31, s[30:31] offset:0 sc0 sc1
    global_load_dwordx4 v[60:63], v31, s[30:31] offset:1024 sc0 sc1
    global_load_dwordx4 v[64:67], v31, s[30:31] offset:2048 sc0 sc1
    global_load_dwordx4 v[68:71], v31, s[30:31] offset:3072 sc0 sc1
    global_load_dwordx4 v[72:75], v32, s[30:31] offset:0 sc0 sc1
    global_load_dwordx4 v[76:79], v32, s[30:31] offset:1024 sc0 sc1
    global_load_dwordx4 v[80:83], v32, s[30:31] offset:2048 sc0 sc1
    global_load_dwordx4 v[84:87], v32, s[30:31] offset:3072 sc0 sc1
    global_load_dwordx4 v[88:91], v33, s[30:31] offset:0 sc0 sc1
    global_load_dwordx4 v[92:95], v33, s[30:31] offset:1024 sc0 sc1
    global_load_dwordx4 v[96:99], v33, s[30:31] offset:2048 sc0 sc1
    global_load_dwordx4 v[100:103], v33, s[30:31] offset:3072 sc0 sc1
    s_waitcnt vmcnt(0)
    v_xor_b32 v204, v43, v225
    v_xor_b32 v205, v47, v225
    v_or_b32 v204, v204, v205
    v_xor_b32 v205, v51, v225
    v_or_b32 v204, v204, v205
    v_xor_b32 v205, v55, v225
    v_or_b32 v204, v204, v205
    v_xor_b32 v205, v59, v225
    v_or_b32 v204, v204, v205
    v_xor_b32 v205, v63, v225
    v_or_b32 v204, v204, v205
    v_xor_b32 v205, v67, v225
    v_or_b32 v204, v204, v205
    v_xor_b32 v205, v71, v225
    v_or_b32 v204, v204, v205
    v_xor_b32 v205, v75, v225
    v_or_b32 v204, v204, v205
    v_xor_b32 v205, v79, v225
    v_or_b32 v204, v204, v205
    v_xor_b32 v205, v83, v225
    v_or_b32 v204, v204, v205
    v_xor_b32 v205, v87, v225
    v_or_b32 v204, v204, v205
    v_xor_b32 v205, v91, v225
    v_or_b32 v204, v204, v205
    v_xor_b32 v205, v95, v225
    v_or_b32 v204, v204, v205
    v_xor_b32 v205, v99, v225
    v_or_b32 v204, v204, v205
    v_xor_b32 v205, v103, v225
    v_or_b32 v204, v204, v205
    v_cmp_ne_u32 vcc, 0, v204
    s_sub_u32 s53, s53, 1
    s_cbranch_scc1 L_poll_done
    s_nop 3
    s_cbranch_vccnz L_poll
L_poll_done:
    s_cmp_lg_u32 s50, 0
    s_cbranch_scc1 L_no_upd
    s_mov_b64 exec, 1
    global_store_dword v226, v225, s[30:31] sc0 sc1
    s_mov_b64 exec, -1
L_no_upd:
    v_max_f32 v206, v42, v46
    v_max3_f32 v206, v206, v50, v54
    v_max3_f32 v206, v206, v58, v62
    v_max3_f32 v206, v206, v66, v70
    v_max3_f32 v206, v206, v74, v78
    v_max3_f32 v206, v206, v82, v86
    v_max3_f32 v206, v206, v90, v94
    v_max3_f32 v206, v206, v98, v102
    s_nop 1
    v_mov_b32_dpp v206, v206 quad_perm:[0,0,2,2] row_mask:0xf bank_mask:0xf
    s_nop 1
    v_sub_f32_dpp v43, v42, v206 quad_perm:[0,0,2,2] row_mask:0xf bank_mask:0xf
    v_sub_f32_dpp v47, v46, v206 quad_perm:[0,0,2,2] row_mask:0xf bank_mask:0xf
    v_sub_f32_dpp v51, v50, v206 quad_perm:[0,0,2,2] row_mask:0xf bank_mask:0xf
    v_sub_f32_dpp v55, v54, v206 quad_perm:[0,0,2,2] row_mask:0xf bank_mask:0xf
    v_sub_f32_dpp v59, v58, v206 quad_perm:[0,0,2,2] row_mask:0xf bank_mask:0xf
    v_sub_f32_dpp v63, v62, v206 quad_perm:[0,0,2,2] row_mask:0xf bank_mask:0xf
    v_sub_f32_dpp v67, v66, v206 quad_perm:[0,0,2,2] row_mask:0xf bank_mask:0xf
    v_sub_f32_dpp v71, v70, v206 quad_perm:[0,0,2,2] row_mask:0xf bank_mask:0xf
    v_sub_f32_dpp v75, v74, v206 quad_perm:[0,0,2,2] row_mask:0xf bank_mask:0xf
    v_sub_f32_dpp v79, v78, v206 quad_perm:[0,0,2,2] row_mask:0xf bank_mask:0xf
    v_sub_f32_dpp v83, v82, v206 quad_perm:[0,0,2,2] row_mask:0xf bank_mask:0xf
    v_sub_f32_dpp v87, v86, v206 quad_perm:[0,0,2,2] row_mask:0xf bank_mask:0xf
    v_sub_f32_dpp v91, v90, v206 quad_perm:[0,0,2,2] row_mask:0xf bank_mask:0xf
    v_sub_f32_dpp v95, v94, v206 quad_perm:[0,0,2,2] row_mask:0xf bank_mask:0xf
    v_sub_f32_dpp v99, v98, v206 quad_perm:[0,0,2,2] row_mask:0xf bank_mask:0xf
    v_sub_f32_dpp v103, v102, v206 quad_perm:[0,0,2,2] row_mask:0xf bank_mask:0xf
    v_exp_f32 v43, v43
    v_exp_f32 v47, v47
    v_exp_f32 v51, v51
    v_exp_f32 v55, v55
    v_exp_f32 v59, v59
    v_exp_f32 v63, v63
    v_exp_f32 v67, v67
    v_exp_f32 v71, v71
    v_exp_f32 v75, v75
    v_exp_f32 v79, v79
    v_exp_f32 v83, v83
    v_exp_f32 v87, v87
    v_exp_f32 v91, v91
    v_exp_f32 v95, v95
    v_exp_f32 v99, v99
    v_exp_f32 v103, v103
    v_mul_f32_dpp v207, v42, v43 quad_perm:[1,1,3,3] row_mask:0xf bank_mask:0xf
    v_mul_f32 v204, v43, v40
    v_mul_f32 v205, v43, v41
    v_fmac_f32_dpp v207, v46, v47 quad_perm:[1,1,3,3] row_mask:0xf bank_mask:0xf
    v_fmac_f32 v204, v47, v44
    v_fmac_f32 v205, v47, v45
    v_fmac_f32_dpp v207, v50, v51 quad_perm:[1,1,3,3] row_mask:0xf bank_mask:0xf
    v_fmac_f32 v204, v51, v48
    v_fmac_f32 v205, v51, v49
    v_fmac_f32_dpp v207, v54, v55 quad_perm:[1,1,3,3] row_mask:0xf bank_mask:0xf
    v_fmac_f32 v204, v55, v52
    v_fmac_f32 v205, v55, v53
    v_fmac_f32_dpp v207, v58, v59 quad_perm:[1,1,3,3] row_mask:0xf bank_mask:0xf
    v_fmac_f32 v204, v59, v56
    v_fmac_f32 v205, v59, v57
    v_fmac_f32_dpp v207, v62, v63 quad_perm:[1,1,3,3] row_mask:0xf bank_mask:0xf
    v_fmac_f32 v204, v63, v60
    v_fmac_f32 v205, v63, v61
    v_fmac_f32_dpp v207, v66, v67 quad_perm:[1,1,3,3] row_mask:0xf bank_mask:0xf
    v_fmac_f32 v204, v67, v64
    v_fmac_f32 v205, v67, v65
    v_fmac_f32_dpp v207, v70, v71 quad_perm:[1,1,3,3] row_mask:0xf bank_mask:0xf
    v_fmac_f32 v204, v71, v68
    v_fmac_f32 v205, v71, v69
    v_fmac_f32_dpp v207, v74, v75 quad_perm:[1,1,3,3] row_mask:0xf bank_mask:0xf
    v_fmac_f32 v204, v75, v72
    v_fmac_f32 v205, v75, v73
    v_fmac_f32_dpp v207, v78, v79 quad_perm:[1,1,3,3] row_mask:0xf bank_mask:0xf
    v_fmac_f32 v204, v79, v76
    v_fmac_f32 v205, v79, v77
    v_fmac_f32_dpp v207, v82, v83 quad_perm:[1,1,3,3] row_mask:0xf bank_mask:0xf
    v_fmac_f32 v204, v83, v80
    v_fmac_f32 v205, v83, v81
    v_fmac_f32_dpp v207, v86, v87 quad_perm:[1,1,3,3] row_mask:0xf bank_mask:0xf
    v_fmac_f32 v204, v87, v84
    v_fmac_f32 v205, v87, v85
    v_fmac_f32_dpp v207, v90, v91 quad_perm:[1,1,3,3] row_mask:0xf bank_mask:0xf
    v_fmac_f32 v204, v91, v88
    v_fmac_f32 v205, v91, v89
    v_fmac_f32_dpp v207, v94, v95 quad_perm:[1,1,3,3] row_mask:0xf bank_mask:0xf
    v_fmac_f32 v204, v95, v92
    v_fmac_f32 v205, v95, v93
    v_fmac_f32_dpp v207, v98, v99 quad_perm:[1,1,3,3] row_mask:0xf bank_mask:0xf
    v_fmac_f32 v204, v99, v96
    v_fmac_f32 v205, v99, v97
    v_fmac_f32_dpp v207, v102, v103 quad_perm:[1,1,3,3] row_mask:0xf bank_mask:0xf
    v_fmac_f32 v204, v103, v100
    v_fmac_f32 v205, v103, v101
    v_rcp_f32 v207, v207
    s_nop 0
    v_mul_f32 v204, v204, v207
    v_mul_f32 v205, v205, v207
    v_cvt_pk_bf16_f32 v204, v204, v205
    global_store_dword v25, v204, s[26:27]
L_end:
    s_endpgm
.fill 64, 4, 0xbf800000
.p2align 7
.type L_const,@object
L_const:
.long 0x3f800000
.long 0x3f5dafd7
.long 0x3f3ff911
.long 0x3f263de0
.long 0x3f0ff59a
.long 0x3ef953cf
.long 0x3ed7e89b
.long 0x3ebaf81b
.long 0x3ea1e89b
.long 0x3e8c3504
.long 0x3e72d423
.long 0x3e5247ed
.long 0x3e361887
.long 0x3e1db040
.long 0x3e088d77
.long 0x3dec7fd6
.long 0x3dcccccd
.long 0x3db15978
.long 0x3d99940d
.long 0x3d84fe4d
.long 0x3d6655c2
.long 0x3d47763f
.long 0x3d2cba15
.long 0x3d159348
.long 0x3d0186e3
.long 0x3ce054d2
.long 0x3cc2434f
.long 0x3ca8398b
.long 0x3c91ad39
.long 0x3c7c4d33
.long 0x3c5a7bf2
.long 0x3c3d3311
.long 0x3c23d70a
.long 0x3c0de12d
.long 0x3bf5b9b0
.long 0x3bd4ca15
.long 0x3bb8449c
.long 0x3b9f91cc
.long 0x3b8a2e77
.long 0x3b6f520e
.long 0x3b4f3e38
.long 0x3b33770f
.long 0x3b1b690d
.long 0x3b06946f
.long 0x3ae91528
.long 0x3ac9d75c
.long 0x3aaec98e
.long 0x3a975c0e
.long 0x3a83126f
.long 0x3a6301e2
.long 0x3a44948c
.long 0x3a2a3b44
.long 0x3a136a16
.long 0x39ff4fac
.long 0x39dd1725
.long 0x39bf74d7
.long 0x39a5cb60
.long 0x398f9272
.long 0x3978a815
.long 0x395753e4
.long 0x393a7753
.long 0x39217916
.long 0x390bd472
.long 0x38f22ce2
.long 0x3f53bf25
.long 0xbf6fbf58
.long 0x3ef53f59
.long 0x3f71bd85
.long 0x3f803cb0
.long 0xbe8e3f22
.long 0x3b8d3ee3
.long 0xbf773f0d
.long 0x3f46bf28
.long 0xbf0f3d69
.long 0xbf7fbeb9
.long 0xbf4a3f7d
.long 0xbea13e22
.long 0x3e043f5c
.long 0x3f643ed3
.long 0x3f71bf3f
.long 0xbe793f79
.long 0xbf7a3e26
.long 0xbf14bef9
.long 0x3d88bf80
.long 0xbf683f38
.long 0xbee33f57
.long 0x3f80bed5
.long 0xbf80bd95
.long 0x3f31bea9
.long 0x3f123f7d
.long 0xbf2abdd9
.long 0xbf7dbf74
.long 0xbf1fbf5a
.long 0xbde3beba
.long 0x3e9c3de9
.long 0x3f163eec
.long 0xbf11bf43
.long 0xbeb8bf0a
.long 0xbf613f09
.long 0x3eadbf7f
.long 0xbd6c3f80
.long 0xbf763f47
.long 0xbf80bf65
.long 0xbe85bf56
.long 0xbf233f41
.long 0xbf55bf80
.long 0x3ddb3f6f
.long 0xbf1ebe27
.long 0xbf733f7d
.long 0xbf7ebf04
.long 0x3ee93f69
.long 0x3eab3f2a
.long 0x3f783e68
.long 0x3e5cbf7d
.long 0x3f513f60
.long 0xbf7f3c86
.long 0xbeda3f32
.long 0xbf663f0b
.long 0x3d413f69
.long 0xbd0bbf7f
.long 0x3f393f72
.long 0xbf52be10
.long 0xbf40bf7f
.long 0x3e19be9d
.long 0x3f483f06
.long 0x3f7e3f6f
.long 0x3f743f7e
.long 0x3f503f63
.size L_const, 512
.section .rodata,"a"
.p2align 6
.amdhsa_kernel standalone__kv_cache_quant_pre_rope_vs_post_rope__sampling_kernel
  .amdhsa_next_free_vgpr 248
  .amdhsa_next_free_sgpr 100
  .amdhsa_accum_offset 248
  .amdhsa_group_segment_fixed_size 0
  .amdhsa_kernarg_size 112
  .amdhsa_user_sgpr_count 2
  .amdhsa_user_sgpr_kernarg_segment_ptr 1
  .amdhsa_system_sgpr_workgroup_id_x 1
.end_amdhsa_kernel
```
